```python
import torch

def _softmax(x, axis=-1):
    return torch.softmax(x, dim=axis)
def _gelu(x):
    return torch.nn.functional.gelu(x, approximate="tanh")
def _silu(x):
    return torch.nn.functional.silu(x)
def _sigmoid(x):
    return torch.sigmoid(x)
def _layernorm(x, axis=-1, eps=1e-5):
    m = x.mean(dim=axis, keepdim=True)
    v = x.var(dim=axis, keepdim=True, unbiased=False)
    return (x - m) / torch.sqrt(v + eps)
def _scatter_add(tgt, idx, src, axis=0):
    return tgt.clone().index_add_(axis, idx, src)
def _segment_sum(src, seg, n):
    out = torch.zeros((n,) + src.shape[1:], dtype=src.dtype)
    return out.index_add_(0, seg, src)
def _pad(x, pw):
    flat = tuple(v for pair in reversed(pw) for v in pair)
    return torch.nn.functional.pad(x, flat)

kernel_name = 'concat_heads__spectral_gfnet__ssm_conv_h3__prompt'

def setup_inputs():

    _w = (lambda a: (lambda t: t.to(torch.bfloat16) if t.is_floating_point() else t)(torch.as_tensor(a)))
    def _A_setup():
        B, S, D = 1, 2048, 640
        Df = D // 2 + 1
        return {
            "x": _w((lambda *s: torch.randn(*s, dtype=torch.bfloat16) * 0.05)(B, S, D)),
            "w_r": _w((lambda *s: torch.randn(*s, dtype=torch.bfloat16) * 0.05)(S, Df) * 0.02),
            "w_i": _w((lambda *s: torch.randn(*s, dtype=torch.bfloat16) * 0.05)(S, Df) * 0.02),
        }
    _A_in = _A_setup()

    def _B_setup():
        B, S, D = 1, 2048, 640
        ks = 4
        return {
            "q": _w((lambda *s: torch.randn(*s, dtype=torch.bfloat16) * 0.05)(B, S, D)),
            "k": _w((lambda *s: torch.randn(*s, dtype=torch.bfloat16) * 0.1)(B, S, D)),
            "v": _w((lambda *s: torch.randn(*s, dtype=torch.bfloat16) * 0.1)(B, S, D)),
            "shift_k": _w((lambda *s: torch.randn(*s, dtype=torch.bfloat16) * 0.1)(D, ks) * 0.5),
            "ssm_k": _w((lambda *s: torch.randn(*s, dtype=torch.bfloat16) * 0.1)(D, S) * (1.0 / S ** 0.5)),
            "ssm_D": _w((lambda *s: torch.randn(*s, dtype=torch.bfloat16) * 0.1)(D)),
        }
    _B_in = _B_setup()

    return {
        "A_x": _A_in["x"],
        "A_w_r": _A_in["w_r"],
        "A_w_i": _A_in["w_i"],
        "B_q": _B_in["q"],
        "B_k": _B_in["k"],
        "B_v": _B_in["v"],
        "B_shift_k": _B_in["shift_k"],
        "B_ssm_k": _B_in["ssm_k"],
        "B_ssm_D": _B_in["ssm_D"],
    }

def reference(A_x, A_w_r, A_w_i, B_q, B_k, B_v, B_shift_k, B_ssm_k, B_ssm_D):
    def _A_ref(x, w_r, w_i):
        B, S, D = x.shape
        X = (lambda x, axes=(-2,-1): torch.fft.rfft2(x.float(), dim=axes))(x, axes=(-2, -1))
        W = w_r + 1j * w_i
        X = X * W
        y = (lambda x, s, axes=(-2,-1): torch.fft.irfft2(x, s=s, dim=axes).to(torch.bfloat16))(X, (S, D), axes=(-2, -1))
        return y

    def _B_ref(q, k, v, shift_k, ssm_k, ssm_D):
        B, S, D = q.shape
        ks = shift_k.shape[-1]
        k_pad = _pad(k, ((0, 0), (ks - 1, 0), (0, 0)))
        k_shift = torch.zeros_like(k)
        for t in range(ks):
            k_shift = k_shift + k_pad[:, t:t + S, :] * shift_k[:, ks - 1 - t][None, None, :]
        kv = k_shift * v
        L = 2 * S
        kv_pad = _pad(kv, ((0, 0), (0, S), (0, 0)))
        kf_pad = _pad(ssm_k, ((0, 0), (0, S)))
        kv_f = (lambda x, axes=(-2,-1): torch.fft.rfft2(x.float(), dim=axes))(kv_pad[:, None, :, :], axes=(1, 2))
        kf_f = (lambda x, axes=(-2,-1): torch.fft.rfft2(x.float(), dim=axes))(kf_pad[:, None, :], axes=(1, 2))
        kf_f = (lambda x, *d: x.permute(*d))(kf_f, 1, 2, 0)
        y_f = kv_f * kf_f[None, :, :, :]
        y = (lambda x, s, axes=(-2,-1): torch.fft.irfft2(x, s=s, dim=axes).to(torch.bfloat16))(y_f, (1, L), axes=(1, 2))[:, 0, :S, :]
        y = y + kv * ssm_D[None, None, :]
        return q * y

    a = _A_ref(A_x, A_w_r, A_w_i)
    b = _B_ref(B_q, B_k, B_v, B_shift_k, B_ssm_k, B_ssm_D)
    return torch.concatenate([a, b], axis=-1)
```

```asm
; @launch grid=(256,1,1) block=(512,1,1) lds=151680
.amdgcn_target "amdgcn-amd-amdhsa--gfx950"
.text
.globl concat_heads__spectral_gfnet__ssm_conv_h3__prompt_kernel
.p2align 8
.type concat_heads__spectral_gfnet__ssm_conv_h3__prompt_kernel,@function
concat_heads__spectral_gfnet__ssm_conv_h3__prompt_kernel:
    s_load_dwordx16 s[4:19], s[0:1], 0
    s_load_dwordx8 s[20:27], s[0:1], 64
    s_memrealtime s[78:79]
    v_lshrrev_b32 v1, 6, v0
    s_cmp_ge_u32 s2, 256
    s_cbranch_scc1 L_exit
    v_readfirstlane_b32 s28, v1
    v_and_b32 v0, 63, v0
    v_mov_b32 v236, -1
    v_mov_b32 v140, -1
    v_mov_b32 v143, -1
    v_mov_b32 v144, -1
    v_mov_b32 v145, -1
    v_mov_b32 v237, -1
    v_mov_b32 v238, -1
    v_mov_b32 v239, 0x80000000
    s_cmp_lt_u32 s28, 4
    s_cbranch_scc1 L_main
    s_sub_u32 s31, s28, 4
    s_waitcnt lgkmcnt(0)
    s_barrier
    s_branch L_aw
L_main:
    s_cmp_lg_u32 s28, 3
    s_cbranch_scc1 L_nopf
    s_getpc_b64 s[32:33]
L_pc:
    s_bfe_u32 s34, s2, 0x20003
    s_lshl_b32 s34, s34, 13
    v_lshl_add_u32 v2, v0, 7, s34
    v_min_u32 v2, 0x6084, v2
    v_mov_b32 v3, s33
    v_add_co_u32 v2, vcc, s32, v2
    s_nop 1
    v_addc_co_u32 v3, vcc, 0, v3, vcc
    global_load_dword v1, v[2:3], off
    v_lshlrev_b32 v2, 3, v0
    v_mov_b32 v4, 0
    v_mov_b32 v5, 0
    ds_write_b64 v2, v[4:5] offset:61952
    s_waitcnt lgkmcnt(0)
    s_barrier
    s_branch L_srv
L_nopf:
    s_or_b32 s30, s2, s28
    s_cbranch_scc1 L_noep
    v_mov_b32 v2, 0
    s_waitcnt lgkmcnt(0)
    s_or_b32 s30, s78, 1
    v_mov_b32 v3, s30
    s_mov_b64 exec, 1
    global_store_dword v2, v3, s[24:25] sc1
    s_mov_b64 exec, -1
L_noep:
    s_mul_i32 s74, s28, 52
    s_cmp_eq_u32 s28, 0
    s_cselect_b32 s72, 0, 4
    s_add_u32 s74, s74, s72
    s_cmp_eq_u32 s28, 0
    s_cselect_b32 s72, 56, 52
    s_bfm_b64 s[72:73], s72, 0
    s_and_b32 s70, s2, 7
    s_lshl_b32 s70, s70, 3
    s_bfe_u32 s71, s2, 0x30003
    s_add_u32 s70, s70, s71
    s_lshr_b32 s71, s2, 6
    v_add_u32 v4, s74, v0
    v_mul_u32_u24 v6, 205, v4
    v_lshrrev_b32 v6, 13, v6
    v_mul_u32_u24 v5, 40, v6
    v_sub_u32 v4, v4, v5
    s_mul_i32 s30, s71, 40
    v_add_u32 v4, s30, v4
    s_lshl_b32 s30, s70, 2
    v_add_u32 v6, s30, v6
    v_mul_u32_u24 v3, 10240, v6
    v_lshl_add_u32 v3, v4, 3, v3
    v_subrev_u32 v2, 3840, v3
    v_lshlrev_b32 v8, 5, v4
    s_mov_b32 s56, 5120
    s_waitcnt lgkmcnt(0)
    s_mov_b32 s32, s12
    s_mov_b32 s33, s13
    s_mov_b32 s34, 2621440
    s_mov_b32 s35, 0x20000
    s_mov_b32 s36, s14
    s_mov_b32 s37, s15
    s_mov_b32 s38, 2621440
    s_mov_b32 s39, 0x20000
    s_mov_b32 s40, s16
    s_mov_b32 s41, s17
    s_mov_b32 s42, 5120
    s_mov_b32 s43, 0x20000
    s_barrier
    s_mov_b64 exec, s[72:73]
    buffer_load_dwordx2 v[16:17], v3, s[32:35], 0 offen offset:0 nt
    buffer_load_dwordx2 v[18:19], v3, s[32:35], 0 offen offset:1280 nt
    buffer_load_dwordx2 v[20:21], v3, s[32:35], 0 offen offset:2560 nt
    buffer_load_dwordx2 v[22:23], v3, s[32:35], 0 offen offset:3840 nt
    buffer_load_dwordx2 v[24:25], v3, s[32:35], s56 offen offset:0 nt
    buffer_load_dwordx2 v[26:27], v3, s[32:35], s56 offen offset:1280 nt
    buffer_load_dwordx2 v[28:29], v3, s[32:35], s56 offen offset:2560 nt
    buffer_load_dwordx2 v[30:31], v3, s[32:35], s56 offen offset:3840 nt
    buffer_load_dwordx2 v[10:11], v2, s[32:35], 0 offen offset:0 nt
    buffer_load_dwordx2 v[12:13], v2, s[32:35], 0 offen offset:1280 nt
    buffer_load_dwordx2 v[14:15], v2, s[32:35], 0 offen offset:2560 nt
    buffer_load_dwordx4 v[48:51], v8, s[40:43], 0 offen
    buffer_load_dwordx4 v[52:55], v8, s[40:43], 0 offen offset:16
    buffer_load_dwordx2 v[32:33], v3, s[36:39], 0 offen offset:0 nt
    buffer_load_dwordx2 v[34:35], v3, s[36:39], 0 offen offset:1280 nt
    buffer_load_dwordx2 v[36:37], v3, s[36:39], 0 offen offset:2560 nt
    buffer_load_dwordx2 v[38:39], v3, s[36:39], 0 offen offset:3840 nt
    buffer_load_dwordx2 v[40:41], v3, s[36:39], s56 offen offset:0 nt
    buffer_load_dwordx2 v[42:43], v3, s[36:39], s56 offen offset:1280 nt
    buffer_load_dwordx2 v[44:45], v3, s[36:39], s56 offen offset:2560 nt
    buffer_load_dwordx2 v[46:47], v3, s[36:39], s56 offen offset:3840 nt
    s_mov_b64 exec, -1
    s_lshl_b32 s30, s28, 2
    s_add_u32 s30, s30, 62336
    v_mov_b32 v2, s30
    v_mov_b32 v3, 1
    s_mov_b64 exec, 1
    ds_write_b32 v2, v3
    s_mov_b64 exec, -1
    s_add_u32 s44, s26, 3145728
    s_addc_u32 s45, s27, 0
    s_mov_b32 s46, 3276800
    s_mov_b32 s47, 0x20000
    s_add_u32 s48, s26, 13107200
    s_addc_u32 s49, s27, 0
    s_mov_b32 s50, 131072
    s_mov_b32 s51, 0x20000
    v_lshrrev_b32 v7, 2, v4
    v_lshlrev_b32 v7, 16, v7
    v_and_b32 v4, 3, v4
    v_lshl_add_u32 v7, v4, 4, v7
    v_sub_u32 v6, 255, v6
    v_lshrrev_b32 v8, 16, v7
    s_mul_i32 s57, s71, 10
    v_subrev_u32 v8, s57, v8
    v_lshlrev_b32 v8, 6, v8
    v_and_b32 v5, 3, v6
    v_lshl_add_u32 v8, v5, 2, v8
    v_add_u32 v8, 62464, v8
    v_lshl_add_u32 v7, v6, 6, v7
    s_and_b32 s62, s72, 0x88888888
    s_and_b32 s63, s73, 0x88888888
    s_mov_b32 s57, 0
    s_mov_b32 s58, 16384
    s_mov_b32 s59, 32768
    s_mov_b32 s60, 49152
    s_lshl_b32 s61, s71, 6
    s_add_u32 s61, s61, s70
    s_lshl_b32 s61, s61, 7
    s_add_u32 s61, s61, 32768
    s_waitcnt vmcnt(20)
    v_lshlrev_b32 v84, 16, v16
    v_and_b32 v85, 0xffff0000, v16
    v_lshlrev_b32 v86, 16, v17
    v_and_b32 v87, 0xffff0000, v17
    s_waitcnt vmcnt(19)
    v_lshlrev_b32 v88, 16, v18
    v_and_b32 v89, 0xffff0000, v18
    v_lshlrev_b32 v90, 16, v19
    v_and_b32 v91, 0xffff0000, v19
    s_waitcnt vmcnt(18)
    v_lshlrev_b32 v92, 16, v20
    v_and_b32 v93, 0xffff0000, v20
    v_lshlrev_b32 v94, 16, v21
    v_and_b32 v95, 0xffff0000, v21
    s_waitcnt vmcnt(17)
    v_lshlrev_b32 v96, 16, v22
    v_and_b32 v97, 0xffff0000, v22
    v_lshlrev_b32 v98, 16, v23
    v_and_b32 v99, 0xffff0000, v23
    s_waitcnt vmcnt(16)
    v_lshlrev_b32 v100, 16, v24
    v_and_b32 v101, 0xffff0000, v24
    v_lshlrev_b32 v102, 16, v25
    v_and_b32 v103, 0xffff0000, v25
    s_waitcnt vmcnt(15)
    v_lshlrev_b32 v104, 16, v26
    v_and_b32 v105, 0xffff0000, v26
    v_lshlrev_b32 v106, 16, v27
    v_and_b32 v107, 0xffff0000, v27
    s_waitcnt vmcnt(14)
    v_lshlrev_b32 v108, 16, v28
    v_and_b32 v109, 0xffff0000, v28
    v_lshlrev_b32 v110, 16, v29
    v_and_b32 v111, 0xffff0000, v29
    s_waitcnt vmcnt(13)
    v_lshlrev_b32 v112, 16, v30
    v_and_b32 v113, 0xffff0000, v30
    v_lshlrev_b32 v114, 16, v31
    v_and_b32 v115, 0xffff0000, v31
    s_waitcnt vmcnt(12)
    v_lshlrev_b32 v72, 16, v10
    v_and_b32 v73, 0xffff0000, v10
    v_lshlrev_b32 v74, 16, v11
    v_and_b32 v75, 0xffff0000, v11
    s_waitcnt vmcnt(11)
    v_lshlrev_b32 v76, 16, v12
    v_and_b32 v77, 0xffff0000, v12
    v_lshlrev_b32 v78, 16, v13
    v_and_b32 v79, 0xffff0000, v13
    s_waitcnt vmcnt(10)
    v_lshlrev_b32 v80, 16, v14
    v_and_b32 v81, 0xffff0000, v14
    v_lshlrev_b32 v82, 16, v15
    v_and_b32 v83, 0xffff0000, v15
    s_waitcnt vmcnt(9)
    v_lshlrev_b32 v56, 16, v48
    v_lshlrev_b32 v57, 16, v50
    s_waitcnt vmcnt(8)
    v_lshlrev_b32 v58, 16, v52
    v_lshlrev_b32 v59, 16, v54
    v_and_b32 v60, 0xffff0000, v48
    v_and_b32 v61, 0xffff0000, v50
    v_and_b32 v62, 0xffff0000, v52
    v_and_b32 v63, 0xffff0000, v54
    v_lshlrev_b32 v64, 16, v49
    v_lshlrev_b32 v65, 16, v51
    v_lshlrev_b32 v66, 16, v53
    v_lshlrev_b32 v67, 16, v55
    v_and_b32 v68, 0xffff0000, v49
    v_and_b32 v69, 0xffff0000, v51
    v_and_b32 v70, 0xffff0000, v53
    v_and_b32 v71, 0xffff0000, v55
    v_pk_mul_f32 v[72:73], v[72:73], v[68:69]
    v_pk_mul_f32 v[74:75], v[74:75], v[70:71]
    v_pk_fma_f32 v[72:73], v[76:77], v[64:65], v[72:73]
    v_pk_fma_f32 v[74:75], v[78:79], v[66:67], v[74:75]
    v_pk_fma_f32 v[72:73], v[80:81], v[60:61], v[72:73]
    v_pk_fma_f32 v[74:75], v[82:83], v[62:63], v[74:75]
    v_pk_fma_f32 v[72:73], v[84:85], v[56:57], v[72:73]
    v_pk_fma_f32 v[74:75], v[86:87], v[58:59], v[74:75]
    v_pk_mul_f32 v[76:77], v[76:77], v[68:69]
    v_pk_mul_f32 v[78:79], v[78:79], v[70:71]
    v_pk_fma_f32 v[76:77], v[80:81], v[64:65], v[76:77]
    v_pk_fma_f32 v[78:79], v[82:83], v[66:67], v[78:79]
    v_pk_fma_f32 v[76:77], v[84:85], v[60:61], v[76:77]
    v_pk_fma_f32 v[78:79], v[86:87], v[62:63], v[78:79]
    v_pk_fma_f32 v[76:77], v[88:89], v[56:57], v[76:77]
    v_pk_fma_f32 v[78:79], v[90:91], v[58:59], v[78:79]
    v_pk_mul_f32 v[80:81], v[80:81], v[68:69]
    v_pk_mul_f32 v[82:83], v[82:83], v[70:71]
    v_pk_fma_f32 v[80:81], v[84:85], v[64:65], v[80:81]
    v_pk_fma_f32 v[82:83], v[86:87], v[66:67], v[82:83]
    v_pk_fma_f32 v[80:81], v[88:89], v[60:61], v[80:81]
    v_pk_fma_f32 v[82:83], v[90:91], v[62:63], v[82:83]
    v_pk_fma_f32 v[80:81], v[92:93], v[56:57], v[80:81]
    v_pk_fma_f32 v[82:83], v[94:95], v[58:59], v[82:83]
    v_pk_mul_f32 v[84:85], v[84:85], v[68:69]
    v_pk_mul_f32 v[86:87], v[86:87], v[70:71]
    v_pk_fma_f32 v[84:85], v[88:89], v[64:65], v[84:85]
    v_pk_fma_f32 v[86:87], v[90:91], v[66:67], v[86:87]
    v_pk_fma_f32 v[84:85], v[92:93], v[60:61], v[84:85]
    v_pk_fma_f32 v[86:87], v[94:95], v[62:63], v[86:87]
    v_pk_fma_f32 v[84:85], v[96:97], v[56:57], v[84:85]
    v_pk_fma_f32 v[86:87], v[98:99], v[58:59], v[86:87]
    v_pk_mul_f32 v[88:89], v[88:89], v[68:69]
    v_pk_mul_f32 v[90:91], v[90:91], v[70:71]
    v_pk_fma_f32 v[88:89], v[92:93], v[64:65], v[88:89]
    v_pk_fma_f32 v[90:91], v[94:95], v[66:67], v[90:91]
    v_pk_fma_f32 v[88:89], v[96:97], v[60:61], v[88:89]
    v_pk_fma_f32 v[90:91], v[98:99], v[62:63], v[90:91]
    v_pk_fma_f32 v[88:89], v[100:101], v[56:57], v[88:89]
    v_pk_fma_f32 v[90:91], v[102:103], v[58:59], v[90:91]
    v_pk_mul_f32 v[92:93], v[92:93], v[68:69]
    v_pk_mul_f32 v[94:95], v[94:95], v[70:71]
    v_pk_fma_f32 v[92:93], v[96:97], v[64:65], v[92:93]
    v_pk_fma_f32 v[94:95], v[98:99], v[66:67], v[94:95]
    v_pk_fma_f32 v[92:93], v[100:101], v[60:61], v[92:93]
    v_pk_fma_f32 v[94:95], v[102:103], v[62:63], v[94:95]
    v_pk_fma_f32 v[92:93], v[104:105], v[56:57], v[92:93]
    v_pk_fma_f32 v[94:95], v[106:107], v[58:59], v[94:95]
    v_pk_mul_f32 v[96:97], v[96:97], v[68:69]
    v_pk_mul_f32 v[98:99], v[98:99], v[70:71]
    v_pk_fma_f32 v[96:97], v[100:101], v[64:65], v[96:97]
    v_pk_fma_f32 v[98:99], v[102:103], v[66:67], v[98:99]
    v_pk_fma_f32 v[96:97], v[104:105], v[60:61], v[96:97]
    v_pk_fma_f32 v[98:99], v[106:107], v[62:63], v[98:99]
    v_pk_fma_f32 v[96:97], v[108:109], v[56:57], v[96:97]
    v_pk_fma_f32 v[98:99], v[110:111], v[58:59], v[98:99]
    v_pk_mul_f32 v[100:101], v[100:101], v[68:69]
    v_pk_mul_f32 v[102:103], v[102:103], v[70:71]
    v_pk_fma_f32 v[100:101], v[104:105], v[64:65], v[100:101]
    v_pk_fma_f32 v[102:103], v[106:107], v[66:67], v[102:103]
    v_pk_fma_f32 v[100:101], v[108:109], v[60:61], v[100:101]
    v_pk_fma_f32 v[102:103], v[110:111], v[62:63], v[102:103]
    v_pk_fma_f32 v[100:101], v[112:113], v[56:57], v[100:101]
    v_pk_fma_f32 v[102:103], v[114:115], v[58:59], v[102:103]
    v_mov_b32 v9, 62368
    ds_read_b32 v9, v9
    s_waitcnt vmcnt(7)
    v_lshlrev_b32 v116, 16, v32
    v_and_b32 v117, 0xffff0000, v32
    v_lshlrev_b32 v118, 16, v33
    v_and_b32 v119, 0xffff0000, v33
    v_pk_mul_f32 v[116:117], v[116:117], v[72:73]
    v_pk_mul_f32 v[118:119], v[118:119], v[74:75]
    s_waitcnt vmcnt(6)
    v_lshlrev_b32 v120, 16, v34
    v_and_b32 v121, 0xffff0000, v34
    v_lshlrev_b32 v122, 16, v35
    v_and_b32 v123, 0xffff0000, v35
    v_pk_mul_f32 v[120:121], v[120:121], v[76:77]
    v_pk_mul_f32 v[122:123], v[122:123], v[78:79]
    s_waitcnt vmcnt(5)
    v_lshlrev_b32 v124, 16, v36
    v_and_b32 v125, 0xffff0000, v36
    v_lshlrev_b32 v126, 16, v37
    v_and_b32 v127, 0xffff0000, v37
    v_pk_mul_f32 v[124:125], v[124:125], v[80:81]
    v_pk_mul_f32 v[126:127], v[126:127], v[82:83]
    s_waitcnt vmcnt(4)
    v_lshlrev_b32 v128, 16, v38
    v_and_b32 v129, 0xffff0000, v38
    v_lshlrev_b32 v130, 16, v39
    v_and_b32 v131, 0xffff0000, v39
    v_pk_mul_f32 v[128:129], v[128:129], v[84:85]
    v_pk_mul_f32 v[130:131], v[130:131], v[86:87]
    s_waitcnt vmcnt(3)
    v_lshlrev_b32 v132, 16, v40
    v_and_b32 v133, 0xffff0000, v40
    v_lshlrev_b32 v134, 16, v41
    v_and_b32 v135, 0xffff0000, v41
    v_pk_mul_f32 v[132:133], v[132:133], v[88:89]
    v_pk_mul_f32 v[134:135], v[134:135], v[90:91]
    s_waitcnt vmcnt(2)
    v_lshlrev_b32 v136, 16, v42
    v_and_b32 v137, 0xffff0000, v42
    v_lshlrev_b32 v138, 16, v43
    v_and_b32 v139, 0xffff0000, v43
    v_pk_mul_f32 v[136:137], v[136:137], v[92:93]
    v_pk_mul_f32 v[138:139], v[138:139], v[94:95]
    s_waitcnt vmcnt(1)
    v_lshlrev_b32 v140, 16, v44
    v_and_b32 v141, 0xffff0000, v44
    v_lshlrev_b32 v142, 16, v45
    v_and_b32 v143, 0xffff0000, v45
    v_pk_mul_f32 v[140:141], v[140:141], v[96:97]
    v_pk_mul_f32 v[142:143], v[142:143], v[98:99]
    s_waitcnt vmcnt(0)
    v_lshlrev_b32 v144, 16, v46
    v_and_b32 v145, 0xffff0000, v46
    v_lshlrev_b32 v146, 16, v47
    v_and_b32 v147, 0xffff0000, v47
    v_pk_mul_f32 v[144:145], v[144:145], v[100:101]
    v_pk_mul_f32 v[146:147], v[146:147], v[102:103]
    s_waitcnt lgkmcnt(0)
    v_readfirstlane_b32 s29, v9
    s_nop 1
    s_cmp_lg_u32 s29, 0
    s_cbranch_scc1 Lhe_1
    v_lshlrev_b32 v4, 2, v0
    s_mov_b64 exec, 1
    s_mov_b32 s30, 1048576
Llw_2:
    ds_read_b32 v5, v4 offset:62368
    s_waitcnt lgkmcnt(0)
    v_cmp_eq_u32 vcc, 0, v5
    s_sub_u32 s30, s30, 1
    s_cbranch_scc1 Llwd_3
    s_cbranch_vccnz Llw_2
Llwd_3:
    v_readfirstlane_b32 s29, v5
    s_mov_b64 exec, -1
    s_nop 0
    v_mov_b32 v9, s29
Lhe_1:
    v_cvt_pk_bf16_f32 v151, v120, v116
    v_cvt_pk_bf16_f32 v155, v121, v117
    v_cvt_pk_bf16_f32 v159, v122, v118
    v_cvt_pk_bf16_f32 v163, v123, v119
    s_mov_b64 exec, s[62:63]
    ds_write2_b32 v8, v151, v155 offset0:0 offset1:4
    ds_write2_b32 v8, v159, v163 offset0:8 offset1:12
    v_mov_b32 v151, v9
    v_mov_b32 v155, v9
    v_mov_b32 v159, v9
    v_mov_b32 v163, v9
    s_mov_b64 exec, -1
    s_lshl_b32 s30, s28, 2
    s_add_u32 s30, s30, 62400
    v_mov_b32 v4, s30
    v_mov_b32 v5, 1
    s_mov_b64 exec, 1
    ds_write_b32 v4, v5
    s_mov_b64 exec, -1
    s_mov_b64 exec, s[72:73]
    v_cvt_pk_bf16_f32 v148, v144, v140
    v_cvt_pk_bf16_f32 v149, v136, v132
    v_cvt_pk_bf16_f32 v150, v128, v124
    buffer_store_dwordx4 v[148:151], v7, s[44:47], s57 offen sc1
    v_cvt_pk_bf16_f32 v152, v145, v141
    v_cvt_pk_bf16_f32 v153, v137, v133
    v_cvt_pk_bf16_f32 v154, v129, v125
    buffer_store_dwordx4 v[152:155], v7, s[44:47], s58 offen sc1
    v_cvt_pk_bf16_f32 v156, v146, v142
    v_cvt_pk_bf16_f32 v157, v138, v134
    v_cvt_pk_bf16_f32 v158, v130, v126
    buffer_store_dwordx4 v[156:159], v7, s[44:47], s59 offen sc1
    v_cvt_pk_bf16_f32 v160, v147, v143
    v_cvt_pk_bf16_f32 v161, v139, v135
    v_cvt_pk_bf16_f32 v162, v131, v127
    buffer_store_dwordx4 v[160:163], v7, s[44:47], s60 offen sc1
    s_mov_b64 exec, -1
    s_mul_i32 s74, s28, 52
    s_cmp_eq_u32 s28, 0
    s_cselect_b32 s72, 0, 4
    s_add_u32 s74, s74, s72
    s_cmp_eq_u32 s28, 0
    s_cselect_b32 s72, 56, 52
    s_bfm_b64 s[72:73], s72, 0
    s_and_b32 s70, s2, 7
    s_lshl_b32 s70, s70, 3
    s_bfe_u32 s71, s2, 0x30003
    s_add_u32 s70, s70, s71
    s_lshr_b32 s71, s2, 6
    v_add_u32 v234, s74, v0
    v_mul_u32_u24 v233, 205, v234
    v_lshrrev_b32 v233, 13, v233
    v_mul_u32_u24 v235, 40, v233
    v_sub_u32 v234, v234, v235
    s_mul_i32 s30, s71, 40
    v_add_u32 v234, s30, v234
    s_lshl_b32 s30, s70, 2
    v_add_u32 v233, s30, v233
    v_mul_u32_u24 v236, 10240, v233
    v_lshl_add_u32 v236, v234, 3, v236
    v_mul_u32_u24 v238, 20480, v233
    v_lshl_add_u32 v238, v234, 3, v238
    v_lshrrev_b32 v237, 2, v234
    v_lshlrev_b32 v237, 16, v237
    v_and_b32 v234, 3, v234
    v_lshl_add_u32 v237, v234, 4, v237
    v_lshl_add_u32 v237, v233, 6, v237
    s_mov_b32 s69, 5120
    s_mov_b64 exec, s[72:73]
    v_mov_b32 v239, v236
    s_mov_b64 exec, -1
    s_waitcnt vmcnt(0)
    s_lshl_b32 s30, s28, 2
    s_add_u32 s30, s30, 62048
    v_mov_b32 v4, s30
    v_mov_b32 v5, 1
    s_mov_b64 exec, 1
    ds_write_b32 v4, v5
    s_mov_b64 exec, -1
    s_cmp_lt_u32 s2, 88
    s_cbranch_scc1 L_a2m
    s_cmp_lt_u32 s2, 248
    s_cbranch_scc1 L_b2
    s_branch L_q
.p2align 6
L_aw:
    v_and_b32 v2, 15, v0
    v_lshrrev_b32 v3, 4, v0
    v_cvt_f32_u32 v8, v2
    v_cvt_f32_u32 v9, v3
    v_cvt_f32_u32 v7, s31
    v_mul_f32 v7, 0x3e000000, v7
    v_mul_f32 v4, 0x3d4ccccd, v8
    v_mul_f32 v5, v9, v7
    v_add_f32 v5, v5, v5
    v_add_f32 v6, v5, v7
    v_and_b32 v13, 1, v0
    v_mul_u32_u24 v13, 0x8000, v13
    v_lshl_or_b32 v13, v13, 16, v13
    v_cos_f32 v68, v5
    v_sin_f32 v70, v5
    v_add_f32 v5, v5, v4
    v_cos_f32 v72, v6
    v_sin_f32 v74, v6
    v_add_f32 v6, v6, v4
    v_cos_f32 v69, v5
    v_sin_f32 v71, v5
    v_add_f32 v5, v5, v4
    v_cos_f32 v73, v6
    v_sin_f32 v75, v6
    v_add_f32 v6, v6, v4
    v_cvt_pk_bf16_f32 v116, v68, v69
    v_cvt_pk_bf16_f32 v128, -v70, -v71
    v_xor_b32 v121, v13, v116
    v_xor_b32 v133, v13, v128
    v_cvt_pk_bf16_f32 v140, v72, v73
    v_cvt_pk_bf16_f32 v152, -v74, -v75
    v_xor_b32 v145, v13, v140
    v_xor_b32 v157, v13, v152
    v_cos_f32 v68, v5
    v_sin_f32 v70, v5
    v_add_f32 v5, v5, v4
    v_cos_f32 v72, v6
    v_sin_f32 v74, v6
    v_add_f32 v6, v6, v4
    v_cos_f32 v69, v5
    v_sin_f32 v71, v5
    v_add_f32 v5, v5, v4
    v_cos_f32 v73, v6
    v_sin_f32 v75, v6
    v_add_f32 v6, v6, v4
    v_cvt_pk_bf16_f32 v117, v68, v69
    v_cvt_pk_bf16_f32 v129, -v70, -v71
    v_xor_b32 v122, v13, v117
    v_xor_b32 v134, v13, v129
    v_cvt_pk_bf16_f32 v141, v72, v73
    v_cvt_pk_bf16_f32 v153, -v74, -v75
    v_xor_b32 v146, v13, v141
    v_xor_b32 v158, v13, v153
    v_cos_f32 v68, v5
    v_sin_f32 v70, v5
    v_add_f32 v5, v5, v4
    v_cos_f32 v72, v6
    v_sin_f32 v74, v6
    v_add_f32 v6, v6, v4
    v_cos_f32 v69, v5
    v_sin_f32 v71, v5
    v_add_f32 v5, v5, v4
    v_cos_f32 v73, v6
    v_sin_f32 v75, v6
    v_add_f32 v6, v6, v4
    v_cvt_pk_bf16_f32 v118, v68, v69
    v_cvt_pk_bf16_f32 v130, -v70, -v71
    v_xor_b32 v123, v13, v118
    v_xor_b32 v135, v13, v130
    v_cvt_pk_bf16_f32 v142, v72, v73
    v_cvt_pk_bf16_f32 v154, -v74, -v75
    v_xor_b32 v147, v13, v142
    v_xor_b32 v159, v13, v154
    v_cos_f32 v68, v5
    v_sin_f32 v70, v5
    v_add_f32 v5, v5, v4
    v_cos_f32 v72, v6
    v_sin_f32 v74, v6
    v_add_f32 v6, v6, v4
    v_cos_f32 v69, v5
    v_sin_f32 v71, v5
    v_add_f32 v5, v5, v4
    v_cos_f32 v73, v6
    v_sin_f32 v75, v6
    v_add_f32 v6, v6, v4
    v_cvt_pk_bf16_f32 v119, v68, v69
    v_cvt_pk_bf16_f32 v131, -v70, -v71
    v_xor_b32 v124, v13, v119
    v_xor_b32 v136, v13, v131
    v_cvt_pk_bf16_f32 v143, v72, v73
    v_cvt_pk_bf16_f32 v155, -v74, -v75
    v_xor_b32 v148, v13, v143
    v_xor_b32 v160, v13, v155
    v_cos_f32 v68, v5
    v_sin_f32 v70, v5
    v_add_f32 v5, v5, v4
    v_cos_f32 v72, v6
    v_sin_f32 v74, v6
    v_add_f32 v6, v6, v4
    v_cos_f32 v69, v5
    v_sin_f32 v71, v5
    v_add_f32 v5, v5, v4
    v_cos_f32 v73, v6
    v_sin_f32 v75, v6
    v_add_f32 v6, v6, v4
    v_cvt_pk_bf16_f32 v120, v68, v69
    v_cvt_pk_bf16_f32 v132, -v70, -v71
    v_xor_b32 v125, v13, v120
    v_xor_b32 v137, v13, v132
    v_cvt_pk_bf16_f32 v144, v72, v73
    v_cvt_pk_bf16_f32 v156, -v74, -v75
    v_xor_b32 v149, v13, v144
    v_xor_b32 v161, v13, v156
    v_mov_b32 v126, 0
    v_mov_b32 v127, 0
    v_mov_b32 v138, 0
    v_mov_b32 v139, 0
    v_mov_b32 v150, 0
    v_mov_b32 v151, 0
    v_mov_b32 v162, 0
    v_mov_b32 v163, 0
    v_mov_b32 v30, 0
    v_mov_b32 v31, 0
    v_mov_b32 v42, 0
    v_mov_b32 v43, 0
    v_mov_b32 v54, 0
    v_mov_b32 v55, 0
    v_mov_b32 v66, 0
    v_mov_b32 v67, 0
    v_lshlrev_b32 v5, 2, v0
    s_mov_b64 exec, 7
    s_mov_b32 s30, 1048576
Llw_4:
    ds_read_b32 v6, v5 offset:62336
    s_waitcnt lgkmcnt(0)
    v_cmp_eq_u32 vcc, 0, v6
    s_sub_u32 s30, s30, 1
    s_cbranch_scc1 Llwd_5
    s_cbranch_vccnz Llw_4
Llwd_5:
    s_mov_b64 exec, -1
    s_sub_u32 s31, s28, 4
    s_and_b32 s52, s31, 1
    s_lshl_b32 s52, s52, 2
    s_lshr_b32 s53, s31, 1
    s_add_u32 s52, s52, s53
    s_lshl_b32 s52, s52, 8
    s_add_u32 s52, s52, s2
    s_mul_i32 s52, s52, 1280
    s_mul_i32 s53, s31, 2560
    s_add_u32 s53, s53, 51712
    v_lshlrev_b32 v228, 4, v0
    v_add_u32 v230, 654080, v228
    v_cmp_le_u32 vcc, 16, v0
    s_mov_b32 m0, s53
    s_mov_b32 s34, 2621440
    s_mov_b32 s35, 0x20000
    v_cndmask_b32 v229, v228, v230, vcc
    s_mov_b32 s32, s4
    s_mov_b32 s33, s5
    buffer_load_dwordx4 v228, s[32:35], s52 offen nt lds
    buffer_load_dwordx4 v229, s[32:35], s52 offen offset:1024 nt lds
    s_mov_b32 exec_hi, 0
    buffer_load_dwordx4 v230, s[32:35], s52 offen offset:2048 nt lds
    s_mov_b64 exec, -1
    v_and_b32 v4, 3, v0
    v_lshrrev_b32 v5, 2, v2
    v_lshlrev_b32 v10, 6, v5
    v_lshl_add_u32 v10, v4, 3, v10
    v_add_u32 v10, 51712, v10
    v_mul_u32_u24 v6, 1280, v3
    v_add_u32 v10, v10, v6
    v_mul_u32_u24 v6, 80, v2
    v_lshl_add_u32 v6, v3, 4, v6
    s_mul_i32 s54, s31, 1344
    s_add_u32 s54, s54, 63104
    v_add_u32 v11, s54, v6
    s_sub_u32 s55, 4, s31
    s_and_b32 s55, s55, 3
    s_mul_i32 s55, s55, 1344
    s_add_u32 s55, s55, 64372
    v_sub_u32 v12, s55, v6
    s_cmp_eq_u32 s31, 0
    s_cselect_b32 s56, 0, 5376
    s_cselect_b32 s57, 5376, 0
    s_mul_i32 s54, s31, 2688
    s_add_u32 s54, s54, 63104
    s_lshl_b32 s58, s31, 15
    s_lshl_b32 s59, s2, 6
    s_add_u32 s58, s58, s59
    s_mov_b32 s79, 1344
    v_add_u32 v4, 0, v0
    v_mov_b32 v5, 0
    v_lshrrev_b32 v6, 2, v4
    v_lshlrev_b32 v17, 2, v4
    v_sub_u32 v17, v17, v6
    v_lshlrev_b32 v17, 2, v17
    v_mad_u32_u24 v17, v5, s79, v17
    v_add_u32 v17, s54, v17
    v_lshlrev_b32 v6, 17, v6
    v_lshl_add_u32 v6, v5, 14, v6
    v_and_b32 v5, 3, v0
    v_lshl_add_u32 v14, v5, 4, v6
    v_add_u32 v4, 64, v0
    v_cmp_le_u32 vcc, 88, v4
    s_nop 1
    v_cndmask_b32 v5, 0, 1, vcc
    v_mul_u32_u24 v18, 88, v5
    v_sub_u32 v4, v4, v18
    v_lshrrev_b32 v6, 2, v4
    v_lshlrev_b32 v18, 2, v4
    v_sub_u32 v18, v18, v6
    v_lshlrev_b32 v18, 2, v18
    v_mad_u32_u24 v18, v5, s79, v18
    v_add_u32 v18, s54, v18
    v_lshlrev_b32 v6, 17, v6
    v_lshl_add_u32 v6, v5, 14, v6
    v_and_b32 v5, 3, v0
    v_lshl_add_u32 v15, v5, 4, v6
    v_add_u32 v4, 128, v0
    v_mov_b32 v5, 1
    v_subrev_u32 v4, 88, v4
    v_lshrrev_b32 v6, 2, v4
    v_lshlrev_b32 v19, 2, v4
    v_sub_u32 v19, v19, v6
    v_lshlrev_b32 v19, 2, v19
    v_mad_u32_u24 v19, v5, s79, v19
    v_add_u32 v19, s54, v19
    v_lshlrev_b32 v6, 17, v6
    v_lshl_add_u32 v6, v5, 14, v6
    v_and_b32 v5, 3, v0
    v_lshl_add_u32 v16, v5, 4, v6
    s_mov_b32 s36, s26
    s_mov_b32 s37, s27
    s_mov_b32 s38, 2883584
    s_mov_b32 s39, 0x20000
    s_add_u32 s48, s26, 13107200
    s_addc_u32 s49, s27, 0
    s_mov_b32 s50, 131072
    s_mov_b32 s51, 0x20000
    s_lshl_b32 s68, s2, 7
    s_add_u32 s68, s68, 0
    s_mul_i32 s60, s2, s31
    s_lshl_b32 s61, s2, 2
    s_add_u32 s61, s61, s60
    v_cvt_f32_u32 v76, s60
    v_cvt_f32_u32 v77, s61
    v_mul_f32 v76, 0x3a000000, v76
    v_mul_f32 v77, 0x3a000000, v77
    v_mul_f32 v9, 4.0, v9
    v_mul_f32 v4, 0x3acccccd, v8
    v_mul_f32 v7, 0x3d000000, v8
    v_add_f32 v6, 0x00000000, v9
    v_fma_f32 v68, v6, v4, v76
    v_fma_f32 v72, v6, v4, v77
    v_mul_f32 v69, v6, v7
    v_cos_f32 v196, v68
    v_sin_f32 v197, v68
    v_cos_f32 v212, v72
    v_sin_f32 v213, v72
    v_cos_f32 v70, v69
    v_sin_f32 v71, v69
    s_nop 0
    v_cvt_pk_bf16_f32 v164, v70, v71
    v_cvt_pk_bf16_f32 v172, -v71, v70
    v_cvt_pk_bf16_f32 v180, v70, v71
    v_cvt_pk_bf16_f32 v188, v71, -v70
    v_add_f32 v6, 0x3f800000, v9
    v_fma_f32 v68, v6, v4, v76
    v_fma_f32 v72, v6, v4, v77
    v_mul_f32 v69, v6, v7
    v_cos_f32 v198, v68
    v_sin_f32 v199, v68
    v_cos_f32 v214, v72
    v_sin_f32 v215, v72
    v_cos_f32 v70, v69
    v_sin_f32 v71, v69
    s_nop 0
    v_cvt_pk_bf16_f32 v165, v70, v71
    v_cvt_pk_bf16_f32 v173, -v71, v70
    v_cvt_pk_bf16_f32 v181, -v70, -v71
    v_cvt_pk_bf16_f32 v189, -v71, v70
    v_add_f32 v6, 0x40000000, v9
    v_fma_f32 v68, v6, v4, v76
    v_fma_f32 v72, v6, v4, v77
    v_mul_f32 v69, v6, v7
    v_cos_f32 v200, v68
    v_sin_f32 v201, v68
    v_cos_f32 v216, v72
    v_sin_f32 v217, v72
    v_cos_f32 v70, v69
    v_sin_f32 v71, v69
    s_nop 0
    v_cvt_pk_bf16_f32 v166, v70, v71
    v_cvt_pk_bf16_f32 v174, -v71, v70
    v_cvt_pk_bf16_f32 v182, v70, v71
    v_cvt_pk_bf16_f32 v190, v71, -v70
    v_add_f32 v6, 0x40400000, v9
    v_fma_f32 v68, v6, v4, v76
    v_fma_f32 v72, v6, v4, v77
    v_mul_f32 v69, v6, v7
    v_cos_f32 v202, v68
    v_sin_f32 v203, v68
    v_cos_f32 v218, v72
    v_sin_f32 v219, v72
    v_cos_f32 v70, v69
    v_sin_f32 v71, v69
    s_nop 0
    v_cvt_pk_bf16_f32 v167, v70, v71
    v_cvt_pk_bf16_f32 v175, -v71, v70
    v_cvt_pk_bf16_f32 v183, -v70, -v71
    v_cvt_pk_bf16_f32 v191, -v71, v70
    v_add_f32 v6, 0x41800000, v9
    v_fma_f32 v68, v6, v4, v76
    v_fma_f32 v72, v6, v4, v77
    v_mul_f32 v69, v6, v7
    v_cos_f32 v204, v68
    v_sin_f32 v205, v68
    v_cos_f32 v220, v72
    v_sin_f32 v221, v72
    v_cos_f32 v70, v69
    v_sin_f32 v71, v69
    s_nop 0
    v_cvt_pk_bf16_f32 v168, v70, v71
    v_cvt_pk_bf16_f32 v176, -v71, v70
    v_cvt_pk_bf16_f32 v184, v70, v71
    v_cvt_pk_bf16_f32 v192, v71, -v70
    v_add_f32 v6, 0x41880000, v9
    v_fma_f32 v68, v6, v4, v76
    v_fma_f32 v72, v6, v4, v77
    v_mul_f32 v69, v6, v7
    v_cos_f32 v206, v68
    v_sin_f32 v207, v68
    v_cos_f32 v222, v72
    v_sin_f32 v223, v72
    v_cos_f32 v70, v69
    v_sin_f32 v71, v69
    s_nop 0
    v_cvt_pk_bf16_f32 v169, v70, v71
    v_cvt_pk_bf16_f32 v177, -v71, v70
    v_cvt_pk_bf16_f32 v185, -v70, -v71
    v_cvt_pk_bf16_f32 v193, -v71, v70
    v_add_f32 v6, 0x41900000, v9
    v_fma_f32 v68, v6, v4, v76
    v_fma_f32 v72, v6, v4, v77
    v_mul_f32 v69, v6, v7
    v_cos_f32 v208, v68
    v_sin_f32 v209, v68
    v_cos_f32 v224, v72
    v_sin_f32 v225, v72
    v_cos_f32 v70, v69
    v_sin_f32 v71, v69
    s_nop 0
    v_cvt_pk_bf16_f32 v170, v70, v71
    v_cvt_pk_bf16_f32 v178, -v71, v70
    v_cvt_pk_bf16_f32 v186, v70, v71
    v_cvt_pk_bf16_f32 v194, v71, -v70
    v_add_f32 v6, 0x41980000, v9
    v_fma_f32 v68, v6, v4, v76
    v_fma_f32 v72, v6, v4, v77
    v_mul_f32 v69, v6, v7
    v_cos_f32 v210, v68
    v_sin_f32 v211, v68
    v_cos_f32 v226, v72
    v_sin_f32 v227, v72
    v_cos_f32 v70, v69
    v_sin_f32 v71, v69
    s_nop 0
    v_cvt_pk_bf16_f32 v171, v70, v71
    v_cvt_pk_bf16_f32 v179, -v71, v70
    v_cvt_pk_bf16_f32 v187, -v70, -v71
    v_cvt_pk_bf16_f32 v195, -v71, v70
    v_add_u32 v8, s56, v12
    v_add_u32 v9, s57, v12
    s_waitcnt vmcnt(0)
    s_lshl2_add_u32 s30, s31, 61952
    s_mov_b64 exec, 15
    v_mov_b32 v4, s30
    v_lshlrev_b32 v6, 2, v0
    ds_write_b32 v4, v4
    s_mov_b32 s30, 1048576
Llj_6:
    ds_read_b32 v7, v6 offset:61952
    s_sub_u32 s30, s30, 1
    s_cbranch_scc1 Lljd_7
    s_waitcnt lgkmcnt(0)
    v_cmp_eq_u32 vcc, 0, v7
    s_nop 1
    s_cbranch_vccnz Llj_6
Lljd_7:
    s_mov_b64 exec, -1
    ds_read_b64_tr_b16 v[20:21], v10 offset:0
    ds_read_b64_tr_b16 v[22:23], v10 offset:256
    ds_read_b64_tr_b16 v[24:25], v10 offset:512
    ds_read_b64_tr_b16 v[26:27], v10 offset:768
    ds_read_b64_tr_b16 v[28:29], v10 offset:1024
    ds_read_b64_tr_b16 v[32:33], v10 offset:5120
    ds_read_b64_tr_b16 v[34:35], v10 offset:5376
    ds_read_b64_tr_b16 v[36:37], v10 offset:5632
    ds_read_b64_tr_b16 v[38:39], v10 offset:5888
    ds_read_b64_tr_b16 v[40:41], v10 offset:6144
    ds_read_b64_tr_b16 v[44:45], v10 offset:32
    s_waitcnt lgkmcnt(9)
    v_mfma_f32_16x16x32_bf16 v[68:71], v[20:23], v[116:119], 0
    ds_read_b64_tr_b16 v[46:47], v10 offset:288
    v_mfma_f32_16x16x32_bf16 v[72:75], v[20:23], v[128:131], 0
    ds_read_b64_tr_b16 v[48:49], v10 offset:544
    s_waitcnt lgkmcnt(9)
    v_mfma_f32_16x16x32_bf16 v[68:71], v[24:27], v[120:123], v[68:71]
    ds_read_b64_tr_b16 v[50:51], v10 offset:800
    v_mfma_f32_16x16x32_bf16 v[72:75], v[24:27], v[132:135], v[72:75]
    ds_read_b64_tr_b16 v[52:53], v10 offset:1056
    s_waitcnt lgkmcnt(10)
    v_mfma_f32_16x16x32_bf16 v[68:71], v[28:31], v[124:127], v[68:71]
    ds_read_b64_tr_b16 v[56:57], v10 offset:5152
    v_mfma_f32_16x16x32_bf16 v[72:75], v[28:31], v[136:139], v[72:75]
    ds_read_b64_tr_b16 v[58:59], v10 offset:5408
    s_waitcnt lgkmcnt(10)
    v_mfma_f32_16x16x32_bf16 v[76:79], v[32:35], v[140:143], 0
    ds_read_b64_tr_b16 v[60:61], v10 offset:5664
    v_mfma_f32_16x16x32_bf16 v[80:83], v[32:35], v[152:155], 0
    ds_read_b64_tr_b16 v[62:63], v10 offset:5920
    s_waitcnt lgkmcnt(10)
    v_mfma_f32_16x16x32_bf16 v[76:79], v[36:39], v[144:147], v[76:79]
    ds_read_b64_tr_b16 v[64:65], v10 offset:6176
    v_mfma_f32_16x16x32_bf16 v[80:83], v[36:39], v[156:159], v[80:83]
    s_waitcnt lgkmcnt(10)
    v_mfma_f32_16x16x32_bf16 v[76:79], v[40:43], v[148:151], v[76:79]
    v_mfma_f32_16x16x32_bf16 v[80:83], v[40:43], v[160:163], v[80:83]
    s_waitcnt lgkmcnt(8)
    v_mfma_f32_16x16x32_bf16 v[84:87], v[44:47], v[116:119], 0
    v_mfma_f32_16x16x32_bf16 v[88:91], v[44:47], v[128:131], 0
    s_waitcnt lgkmcnt(6)
    v_mfma_f32_16x16x32_bf16 v[84:87], v[48:51], v[120:123], v[84:87]
    v_mfma_f32_16x16x32_bf16 v[88:91], v[48:51], v[132:135], v[88:91]
    s_nop 0
    v_add_f32 v4, v68, v76
    v_add_f32 v5, v72, v80
    v_sub_f32 v68, v68, v76
    v_sub_f32 v72, v72, v80
    s_waitcnt lgkmcnt(5)
    v_mfma_f32_16x16x32_bf16 v[84:87], v[52:55], v[124:127], v[84:87]
    v_mul_f32 v6, v4, v196
    v_mul_f32 v7, v5, v196
    v_fmac_f32 v6, v5, v197
    v_fma_f32 v7, -v4, v197, v7
    v_mfma_f32_16x16x32_bf16 v[88:91], v[52:55], v[136:139], v[88:91]
    v_cvt_pk_bf16_f32 v100, v6, v7
    v_mul_f32 v76, v68, v212
    v_mul_f32 v80, v72, v212
    v_fmac_f32 v76, v72, v213
    s_waitcnt lgkmcnt(3)
    v_mfma_f32_16x16x32_bf16 v[92:95], v[56:59], v[140:143], 0
    v_fma_f32 v80, -v68, v213, v80
    v_cvt_pk_bf16_f32 v108, v76, v80
    v_add_f32 v4, v69, v77
    v_add_f32 v5, v73, v81
    v_mfma_f32_16x16x32_bf16 v[96:99], v[56:59], v[152:155], 0
    v_sub_f32 v69, v69, v77
    v_sub_f32 v73, v73, v81
    v_mul_f32 v6, v4, v198
    v_mul_f32 v7, v5, v198
    s_waitcnt lgkmcnt(1)
    v_mfma_f32_16x16x32_bf16 v[92:95], v[60:63], v[144:147], v[92:95]
    v_fmac_f32 v6, v5, v199
    v_fma_f32 v7, -v4, v199, v7
    v_cvt_pk_bf16_f32 v101, v6, v7
    v_mul_f32 v77, v69, v214
    v_mfma_f32_16x16x32_bf16 v[96:99], v[60:63], v[156:159], v[96:99]
    v_mul_f32 v81, v73, v214
    v_fmac_f32 v77, v73, v215
    v_fma_f32 v81, -v69, v215, v81
    v_cvt_pk_bf16_f32 v109, v77, v81
    s_waitcnt lgkmcnt(0)
    v_mfma_f32_16x16x32_bf16 v[92:95], v[64:67], v[148:151], v[92:95]
    v_add_f32 v4, v70, v78
    v_add_f32 v5, v74, v82
    v_sub_f32 v70, v70, v78
    v_sub_f32 v74, v74, v82
    v_mfma_f32_16x16x32_bf16 v[96:99], v[64:67], v[160:163], v[96:99]
    v_mul_f32 v6, v4, v200
    v_mul_f32 v7, v5, v200
    v_fmac_f32 v6, v5, v201
    v_fma_f32 v7, -v4, v201, v7
    v_cvt_pk_bf16_f32 v102, v6, v7
    v_mul_f32 v78, v70, v216
    v_mul_f32 v82, v74, v216
    v_fmac_f32 v78, v74, v217
    v_fma_f32 v82, -v70, v217, v82
    v_cvt_pk_bf16_f32 v110, v78, v82
    v_add_f32 v4, v71, v79
    v_add_f32 v5, v75, v83
    v_sub_f32 v71, v71, v79
    v_sub_f32 v75, v75, v83
    v_mul_f32 v6, v4, v202
    v_mul_f32 v7, v5, v202
    v_fmac_f32 v6, v5, v203
    v_fma_f32 v7, -v4, v203, v7
    v_cvt_pk_bf16_f32 v103, v6, v7
    v_mul_f32 v79, v71, v218
    v_mul_f32 v83, v75, v218
    v_fmac_f32 v79, v75, v219
    v_fma_f32 v83, -v71, v219, v83
    v_cvt_pk_bf16_f32 v111, v79, v83
    v_add_f32 v4, v84, v92
    v_add_f32 v5, v88, v96
    v_sub_f32 v84, v84, v92
    v_sub_f32 v88, v88, v96
    v_mul_f32 v6, v4, v204
    v_mul_f32 v7, v5, v204
    v_mfma_f32_16x16x32_bf16 v[20:23], v[100:103], v[164:167], 0
    v_fmac_f32 v6, v5, v205
    v_fma_f32 v7, -v4, v205, v7
    v_cvt_pk_bf16_f32 v104, v6, v7
    v_mul_f32 v92, v84, v220
    v_mul_f32 v96, v88, v220
    v_mfma_f32_16x16x32_bf16 v[24:27], v[100:103], v[172:175], 0
    v_fmac_f32 v92, v88, v221
    v_fma_f32 v96, -v84, v221, v96
    v_cvt_pk_bf16_f32 v112, v92, v96
    v_add_f32 v4, v85, v93
    v_add_f32 v5, v89, v97
    v_mfma_f32_16x16x32_bf16 v[36:39], v[108:111], v[164:167], 0
    v_sub_f32 v85, v85, v93
    v_sub_f32 v89, v89, v97
    v_mul_f32 v6, v4, v206
    v_mul_f32 v7, v5, v206
    v_fmac_f32 v6, v5, v207
    v_mfma_f32_16x16x32_bf16 v[40:43], v[108:111], v[172:175], 0
    v_fma_f32 v7, -v4, v207, v7
    v_cvt_pk_bf16_f32 v105, v6, v7
    v_mul_f32 v93, v85, v222
    v_mul_f32 v97, v89, v222
    v_fmac_f32 v93, v89, v223
    v_mfma_f32_16x16x32_bf16 v[28:31], v[100:103], v[180:183], 0
    v_fma_f32 v97, -v85, v223, v97
    v_cvt_pk_bf16_f32 v113, v93, v97
    v_add_f32 v4, v86, v94
    v_add_f32 v5, v90, v98
    v_sub_f32 v86, v86, v94
    v_mfma_f32_16x16x32_bf16 v[32:35], v[100:103], v[188:191], 0
    v_sub_f32 v90, v90, v98
    v_mul_f32 v6, v4, v208
    v_mul_f32 v7, v5, v208
    v_fmac_f32 v6, v5, v209
    v_fma_f32 v7, -v4, v209, v7
    v_mfma_f32_16x16x32_bf16 v[44:47], v[108:111], v[180:183], 0
    v_cvt_pk_bf16_f32 v106, v6, v7
    v_mul_f32 v94, v86, v224
    v_mul_f32 v98, v90, v224
    v_fmac_f32 v94, v90, v225
    v_fma_f32 v98, -v86, v225, v98
    v_mfma_f32_16x16x32_bf16 v[48:51], v[108:111], v[188:191], 0
    v_cvt_pk_bf16_f32 v114, v94, v98
    v_add_f32 v4, v87, v95
    v_add_f32 v5, v91, v99
    v_sub_f32 v87, v87, v95
    v_sub_f32 v91, v91, v99
    v_mul_f32 v6, v4, v210
    v_mul_f32 v7, v5, v210
    v_fmac_f32 v6, v5, v211
    v_fma_f32 v7, -v4, v211, v7
    v_cvt_pk_bf16_f32 v107, v6, v7
    v_mul_f32 v95, v87, v226
    v_mul_f32 v99, v91, v226
    v_fmac_f32 v95, v91, v227
    v_fma_f32 v99, -v87, v227, v99
    v_cvt_pk_bf16_f32 v115, v95, v99
    v_mov_b32 v13, 62368
    ds_read_b32 v13, v13
    v_mfma_f32_16x16x32_bf16 v[20:23], v[104:107], v[168:171], v[20:23]
    v_mfma_f32_16x16x32_bf16 v[24:27], v[104:107], v[176:179], v[24:27]
    v_mfma_f32_16x16x32_bf16 v[36:39], v[112:115], v[168:171], v[36:39]
    v_mfma_f32_16x16x32_bf16 v[40:43], v[112:115], v[176:179], v[40:43]
    v_mfma_f32_16x16x32_bf16 v[28:31], v[104:107], v[184:187], v[28:31]
    v_mfma_f32_16x16x32_bf16 v[32:35], v[104:107], v[192:195], v[32:35]
    v_mfma_f32_16x16x32_bf16 v[44:47], v[112:115], v[184:187], v[44:47]
    v_mfma_f32_16x16x32_bf16 v[48:51], v[112:115], v[192:195], v[48:51]
    s_nop 1
    v_cvt_pk_bf16_f32 v68, v20, v24
    v_cvt_pk_bf16_f32 v69, v21, v25
    v_cvt_pk_bf16_f32 v70, v22, v26
    v_cvt_pk_bf16_f32 v71, v23, v27
    v_cvt_pk_bf16_f32 v76, v36, v40
    v_cvt_pk_bf16_f32 v77, v37, v41
    v_cvt_pk_bf16_f32 v78, v38, v42
    v_cvt_pk_bf16_f32 v79, v39, v43
    s_mov_b32 exec_hi, 0
    ds_write_b128 v11, v[68:71] offset:0
    ds_write_b128 v11, v[76:79] offset:5376
    s_mov_b32 exec_lo, 0
    s_mov_b32 exec_hi, 0xffff
    ds_write_b64 v11, v[68:69] offset:0
    ds_write_b32 v11, v70 offset:8
    ds_write_b64 v11, v[76:77] offset:5376
    ds_write_b32 v11, v78 offset:5384
    s_mov_b64 exec, -1
    v_cvt_pk_bf16_f32 v72, v28, v32
    v_cvt_pk_bf16_f32 v73, v29, v33
    v_cvt_pk_bf16_f32 v74, v30, v34
    v_cvt_pk_bf16_f32 v75, v31, v35
    v_cvt_pk_bf16_f32 v80, v44, v48
    v_cvt_pk_bf16_f32 v81, v45, v49
    v_cvt_pk_bf16_f32 v82, v46, v50
    v_cvt_pk_bf16_f32 v83, v47, v51
    s_mov_b32 exec_hi, 0xffff
    ds_write_b32 v8, v73 offset:8
    ds_write_b32 v9, v81 offset:8
    s_mov_b32 exec_lo, 0xffff0001
    ds_write_b32 v8, v72 offset:12
    ds_write_b32 v9, v80 offset:12
    s_mov_b32 exec_lo, -1
    s_mov_b32 exec_hi, 0
    ds_write2_b32 v8, v75, v74 offset0:0 offset1:1
    ds_write2_b32 v9, v83, v82 offset0:0 offset1:1
    s_mov_b64 exec, -1
    s_waitcnt lgkmcnt(12)
    v_readfirstlane_b32 s29, v13
    s_mov_b32 s66, 0x88888888
    s_mov_b32 s67, 0x88888888
    s_cmp_lg_u32 s29, 0
    s_cbranch_scc1 Lhe_8
    v_lshlrev_b32 v4, 2, v0
    s_mov_b64 exec, 1
    s_mov_b32 s30, 1048576
Llw_9:
    ds_read_b32 v5, v4 offset:62368
    s_waitcnt lgkmcnt(0)
    v_cmp_eq_u32 vcc, 0, v5
    s_sub_u32 s30, s30, 1
    s_cbranch_scc1 Llwd_10
    s_cbranch_vccnz Llw_9
Llwd_10:
    v_readfirstlane_b32 s29, v5
    s_mov_b64 exec, -1
    s_nop 0
    v_mov_b32 v13, s29
Lhe_8:
    s_lshl2_add_u32 s30, s31, 61984
    s_mov_b64 exec, 15
    v_mov_b32 v4, s30
    v_lshlrev_b32 v6, 2, v0
    ds_write_b32 v4, v4
    s_mov_b32 s30, 1048576
Llj_11:
    ds_read_b32 v7, v6 offset:61984
    s_sub_u32 s30, s30, 1
    s_cbranch_scc1 Lljd_12
    s_waitcnt lgkmcnt(0)
    v_cmp_eq_u32 vcc, 0, v7
    s_nop 1
    s_cbranch_vccnz Llj_11
Lljd_12:
    s_mov_b64 exec, -1
    ds_read2_b32 v[228:229], v17 offset0:0 offset1:1
    ds_read2_b32 v[230:231], v17 offset0:2 offset1:3
    ds_read2_b32 v[232:233], v18 offset0:0 offset1:1
    ds_read2_b32 v[234:235], v18 offset0:2 offset1:3
    ds_read2_b32 v[236:237], v19 offset0:0 offset1:1
    ds_read2_b32 v[238:239], v19 offset0:2 offset1:3
    s_waitcnt lgkmcnt(4)
    v_cndmask_b32 v231, v231, v13, s[66:67]
    buffer_store_dwordx4 v[228:231], v14, s[36:39], s58 offen sc1
    s_waitcnt lgkmcnt(2)
    v_cndmask_b32 v235, v235, v13, s[66:67]
    buffer_store_dwordx4 v[232:235], v15, s[36:39], s58 offen sc1
    s_waitcnt lgkmcnt(0)
    v_cndmask_b32 v239, v239, v13, s[66:67]
    buffer_store_dwordx4 v[236:239], v16, s[36:39], s58 offen sc1
    s_lshl_b32 s30, s31, 2
    s_add_u32 s30, s30, 62160
    v_mov_b32 v4, s30
    v_mov_b32 v5, 1
    s_mov_b64 exec, 1
    ds_write_b32 v4, v5
    s_mov_b64 exec, -1
    s_waitcnt vmcnt(0)
    s_lshl_b32 s30, s31, 2
    s_add_u32 s30, s30, 62016
    v_mov_b32 v4, s30
    v_mov_b32 v5, 1
    s_mov_b64 exec, 1
    ds_write_b32 v4, v5
    s_mov_b64 exec, -1
Lna_13:
L_a3c:
    v_and_b32 v2, 15, v0
    v_lshrrev_b32 v3, 4, v0
    v_lshlrev_b32 v140, 4, v0
    v_mul_u32_u24 v4, 320, v3
    v_lshl_add_u32 v4, v2, 2, v4
    s_mul_i32 s54, s31, 1344
    s_add_u32 s54, s54, 63104
    v_add_u32 v146, s54, v4
    s_sub_u32 s55, 4, s31
    s_and_b32 s55, s55, 3
    s_mul_i32 s55, s55, 1344
    s_add_u32 s55, s55, 64144
    s_cmp_eq_u32 s31, 0
    s_cselect_b32 s56, 0, 5376
    s_cselect_b32 s57, 5376, 0
    s_add_u32 s56, s56, s55
    s_add_u32 s57, s57, s55
    v_sub_u32 v147, s56, v4
    v_sub_u32 v148, s57, v4
    s_mul_i32 s54, s31, 768
    s_add_u32 s54, s54, 73856
    v_add_u32 v149, s54, v140
    s_and_b32 s54, s31, 1
    s_mul_i32 s55, s54, 6144
    s_add_u32 s55, s55, 73856
    v_add_u32 v150, s55, v140
    v_lshrrev_b32 v4, 2, v2
    v_and_b32 v5, 3, v2
    v_lshl_add_u32 v6, v4, 3, v5
    v_cvt_f32_u32 v8, v6
    v_lshlrev_b32 v6, 2, v3
    v_cvt_f32_u32 v9, v6
    v_and_b32 v24, 1, v0
    v_mul_u32_u24 v24, 0x8000, v24
    v_lshl_or_b32 v24, v24, 16, v24
    v_xor_b32 v24, 0x80000000, v24
    s_mul_i32 s60, s2, s31
    s_lshl_b32 s61, s2, 2
    s_add_u32 s61, s61, s60
    v_cvt_f32_u32 v26, s60
    v_cvt_f32_u32 v27, s61
    v_mul_f32 v26, 0x3a000000, v26
    v_mul_f32 v27, 0x3a000000, v27
    v_add_f32 v4, 0x00000000, v8
    v_mul_f32 v5, 0x3acccccd, v4
    v_mul_f32 v4, 0x3d000000, v4
    v_add_f32 v6, 0x00000000, v9
    v_mul_f32 v16, v6, v4
    v_fma_f32 v17, v6, v5, v26
    v_fma_f32 v25, v6, v5, v27
    v_cos_f32 v18, v16
    v_sin_f32 v19, v16
    v_cos_f32 v184, v17
    v_sin_f32 v188, v17
    v_cos_f32 v200, v25
    v_sin_f32 v204, v25
    v_cvt_pk_bf16_f32 v152, v18, -v19
    v_cvt_pk_bf16_f32 v160, v19, v18
    v_xor_b32 v156, v24, v152
    v_xor_b32 v164, v24, v160
    v_add_f32 v6, 0x3f800000, v9
    v_mul_f32 v16, v6, v4
    v_fma_f32 v17, v6, v5, v26
    v_fma_f32 v25, v6, v5, v27
    v_cos_f32 v18, v16
    v_sin_f32 v19, v16
    v_cos_f32 v185, v17
    v_sin_f32 v189, v17
    v_cos_f32 v201, v25
    v_sin_f32 v205, v25
    v_cvt_pk_bf16_f32 v153, v18, -v19
    v_cvt_pk_bf16_f32 v161, v19, v18
    v_xor_b32 v157, v24, v153
    v_xor_b32 v165, v24, v161
    v_add_f32 v6, 0x40000000, v9
    v_mul_f32 v16, v6, v4
    v_fma_f32 v17, v6, v5, v26
    v_fma_f32 v25, v6, v5, v27
    v_cos_f32 v18, v16
    v_sin_f32 v19, v16
    v_cos_f32 v186, v17
    v_sin_f32 v190, v17
    v_cos_f32 v202, v25
    v_sin_f32 v206, v25
    v_cvt_pk_bf16_f32 v154, v18, -v19
    v_cvt_pk_bf16_f32 v162, v19, v18
    v_xor_b32 v158, v24, v154
    v_xor_b32 v166, v24, v162
    v_add_f32 v6, 0x40400000, v9
    v_mul_f32 v16, v6, v4
    v_fma_f32 v17, v6, v5, v26
    v_fma_f32 v25, v6, v5, v27
    v_cos_f32 v18, v16
    v_sin_f32 v19, v16
    v_cos_f32 v187, v17
    v_sin_f32 v191, v17
    v_cos_f32 v203, v25
    v_sin_f32 v207, v25
    v_cvt_pk_bf16_f32 v155, v18, -v19
    v_cvt_pk_bf16_f32 v163, v19, v18
    v_xor_b32 v159, v24, v155
    v_xor_b32 v167, v24, v163
    v_add_f32 v4, 0x40800000, v8
    v_mul_f32 v5, 0x3acccccd, v4
    v_mul_f32 v4, 0x3d000000, v4
    v_add_f32 v6, 0x00000000, v9
    v_mul_f32 v16, v6, v4
    v_fma_f32 v17, v6, v5, v26
    v_fma_f32 v25, v6, v5, v27
    v_cos_f32 v18, v16
    v_sin_f32 v19, v16
    v_cos_f32 v192, v17
    v_sin_f32 v196, v17
    v_cos_f32 v208, v25
    v_sin_f32 v212, v25
    v_cvt_pk_bf16_f32 v168, v18, -v19
    v_cvt_pk_bf16_f32 v176, v19, v18
    v_xor_b32 v172, v24, v168
    v_xor_b32 v180, v24, v176
    v_add_f32 v6, 0x3f800000, v9
    v_mul_f32 v16, v6, v4
    v_fma_f32 v17, v6, v5, v26
    v_fma_f32 v25, v6, v5, v27
    v_cos_f32 v18, v16
    v_sin_f32 v19, v16
    v_cos_f32 v193, v17
    v_sin_f32 v197, v17
    v_cos_f32 v209, v25
    v_sin_f32 v213, v25
    v_cvt_pk_bf16_f32 v169, v18, -v19
    v_cvt_pk_bf16_f32 v177, v19, v18
    v_xor_b32 v173, v24, v169
    v_xor_b32 v181, v24, v177
    v_add_f32 v6, 0x40000000, v9
    v_mul_f32 v16, v6, v4
    v_fma_f32 v17, v6, v5, v26
    v_fma_f32 v25, v6, v5, v27
    v_cos_f32 v18, v16
    v_sin_f32 v19, v16
    v_cos_f32 v194, v17
    v_sin_f32 v198, v17
    v_cos_f32 v210, v25
    v_sin_f32 v214, v25
    v_cvt_pk_bf16_f32 v170, v18, -v19
    v_cvt_pk_bf16_f32 v178, v19, v18
    v_xor_b32 v174, v24, v170
    v_xor_b32 v182, v24, v178
    v_add_f32 v6, 0x40400000, v9
    v_mul_f32 v16, v6, v4
    v_fma_f32 v17, v6, v5, v26
    v_fma_f32 v25, v6, v5, v27
    v_cos_f32 v18, v16
    v_sin_f32 v19, v16
    v_cos_f32 v195, v17
    v_sin_f32 v199, v17
    v_cos_f32 v211, v25
    v_sin_f32 v215, v25
    v_cvt_pk_bf16_f32 v171, v18, -v19
    v_cvt_pk_bf16_f32 v179, v19, v18
    v_xor_b32 v175, v24, v171
    v_xor_b32 v183, v24, v179
    s_cmp_lt_u32 s2, 88
    s_cbranch_scc1 L_a2
    s_branch L_a3
.p2align 6
L_srv:
    s_add_u32 s48, s26, 13107200
    s_addc_u32 s49, s27, 0
    s_mov_b32 s50, 131072
    s_mov_b32 s51, 0x20000
    s_mov_b32 s32, s18
    s_mov_b32 s33, s19
    s_mov_b32 s34, 2621440
    s_mov_b32 s35, 0x20000
    s_mov_b32 s40, s6
    s_mov_b32 s41, s7
    s_mov_b32 s42, 1314816
    s_mov_b32 s43, 0x20000
    s_mov_b32 s44, s8
    s_mov_b32 s45, s9
    s_mov_b32 s46, 1314816
    s_mov_b32 s47, 0x20000
    s_sub_u32 s52, s2, 88
    s_lshr_b32 s53, s52, 2
    s_lshl_b32 s53, s53, 4
    s_and_b32 s54, s52, 3
    s_add_u32 s53, s53, s54
    s_lshl_b32 s53, s53, 12
    v_lshlrev_b32 v7, 4, v0
    s_and_b32 s30, s2, 7
    s_lshl_b32 s30, s30, 7
    s_add_u32 s30, s30, 65536
    s_cmp_lt_u32 s2, 248
    s_cbranch_scc1 Lzc_14
    v_mov_b32 v2, 0
    s_mov_b64 exec, 1
    buffer_store_dword v2, off, s[48:51], s30 sc1
    s_mov_b64 exec, -1
Lzc_14:
    s_lshr_b32 s30, s2, 6
    s_lshl_b32 s30, s30, 2
    s_and_b32 s56, s2, 3
    s_add_u32 s30, s30, s56
    s_lshl_b32 s30, s30, 7
    s_add_u32 s30, s30, 66560
    s_and_b32 s56, s2, 63
    s_cmp_ge_u32 s56, 4
    s_cbranch_scc1 Lzc_15
    v_mov_b32 v2, 0
    s_mov_b64 exec, 1
    buffer_store_dword v2, off, s[48:51], s30 sc1
    s_mov_b64 exec, -1
Lzc_15:
    s_add_u32 s36, s26, 3145728
    s_addc_u32 s37, s27, 0
    s_mov_b32 s38, 3276800
    s_mov_b32 s39, 0x20000
    v_lshrrev_b32 v2, 2, v0
    v_lshlrev_b32 v28, 4, v2
    v_and_b32 v3, 3, v0
    v_lshlrev_b32 v3, 4, v3
    v_lshl_add_u32 v29, v2, 12, v3
    s_and_b32 s56, s2, 7
    s_lshl_b32 s56, s56, 3
    s_bfe_u32 s57, s2, 0x30003
    s_add_u32 s56, s56, s57
    s_sub_u32 s56, 63, s56
    s_lshl_b32 s56, s56, 6
    s_lshr_b32 s57, s2, 6
    s_mul_i32 s57, s57, 163840
    s_add_u32 s56, s56, s57
    s_add_u32 s56, s56, 2621440
    s_add_u32 s57, s56, 65536
    s_add_u32 s58, s56, 131072
    s_mov_b32 s60, 0x88888888
    s_mov_b32 s61, 0x88888888
    v_lshlrev_b32 v2, 2, v0
    s_mov_b64 exec, 7
    s_mov_b32 s30, 1048576
Llw_16:
    ds_read_b32 v3, v2 offset:62336
    s_waitcnt lgkmcnt(0)
    v_cmp_eq_u32 vcc, 0, v3
    s_sub_u32 s30, s30, 1
    s_cbranch_scc1 Llwd_17
    s_cbranch_vccz Llwd_17
    s_sleep 1
    s_branch Llw_16
Llwd_17:
    s_mov_b64 exec, -1
    v_mov_b32 v6, 0
    s_mov_b64 exec, 1
    global_load_dword v6, v6, s[24:25] sc1
    s_mov_b64 exec, -1
    s_waitcnt vmcnt(0)
    v_readfirstlane_b32 s29, v6
    s_mov_b32 s30, 131072
Lep_18:
    s_nop 1
    s_cmp_lg_u32 s29, 0
    s_cbranch_scc1 Lepd_19
    s_sub_u32 s30, s30, 1
    s_cbranch_scc1 Lepd_19
    v_mov_b32 v6, 0
    s_mov_b64 exec, 1
    global_load_dword v6, v6, s[24:25] sc1
    s_mov_b64 exec, -1
    s_waitcnt vmcnt(0)
    v_readfirstlane_b32 s29, v6
    s_branch Lep_18
Lepd_19:
    v_mov_b32 v2, 62368
    v_mov_b32 v3, s29
    s_mov_b64 exec, 1
    ds_write_b32 v2, v3
    s_mov_b64 exec, -1
    v_mov_b32 v5, s29
    v_lshlrev_b32 v2, 2, v0
    s_mov_b64 exec, 7
    s_mov_b32 s30, 1048576
Llw_20:
    ds_read_b32 v3, v2 offset:62400
    s_waitcnt lgkmcnt(0)
    v_cmp_eq_u32 vcc, 0, v3
    s_sub_u32 s30, s30, 1
    s_cbranch_scc1 Llwd_21
    s_cbranch_vccnz Llw_20
Llwd_21:
    s_mov_b64 exec, -1
    ds_read_b128 v[16:19], v28 offset:62464
    ds_read_b128 v[20:23], v28 offset:62720
    ds_read_b128 v[24:27], v28 offset:62976
    s_waitcnt lgkmcnt(2)
    v_cndmask_b32 v19, v19, v5, s[60:61]
    buffer_store_dwordx4 v[16:19], v29, s[36:39], s56 offen sc1
    s_waitcnt lgkmcnt(1)
    v_cndmask_b32 v23, v23, v5, s[60:61]
    buffer_store_dwordx4 v[20:23], v29, s[36:39], s57 offen sc1
    s_waitcnt lgkmcnt(0)
    v_cndmask_b32 v27, v27, v5, s[60:61]
    s_mov_b32 exec_hi, 0
    buffer_store_dwordx4 v[24:27], v29, s[36:39], s58 offen sc1
    s_mov_b64 exec, -1
    s_lshr_b32 s54, s2, 3
    s_lshl_b32 s54, s54, 6
    s_and_b32 s55, s2, 7
    s_add_u32 s54, s54, s55
    s_mul_i32 s54, s54, 642
    v_and_b32 v3, 7, v0
    v_lshlrev_b32 v3, 7, v3
    v_min_u32 v3, 640, v3
    v_lshrrev_b32 v4, 3, v0
    v_mul_u32_u24 v4, 5136, v4
    v_add_u32 v8, v3, v4
    s_mov_b32 exec_lo, 0x3f3f3f3f
    s_mov_b32 exec_hi, 0x3f3f3f3f
    buffer_load_ubyte v1, v8, s[40:43], s54 offen
    buffer_load_ubyte v1, v8, s[44:47], s54 offen
    s_mov_b64 exec, -1
    s_cmp_lt_u32 s2, 88
    s_cbranch_scc1 L_a2m
    s_cmp_ge_u32 s52, 160
    s_cbranch_scc1 L_end3
    v_lshlrev_b32 v2, 2, v0
    s_mov_b64 exec, 7
    s_mov_b32 s30, 1048576
Llw_22:
    ds_read_b32 v3, v2 offset:62048
    s_waitcnt lgkmcnt(0)
    v_cmp_eq_u32 vcc, 0, v3
    s_sub_u32 s30, s30, 1
    s_cbranch_scc1 Llwd_23
    s_cbranch_vccz Llwd_23
    s_sleep 1
    s_branch Llw_22
Llwd_23:
    s_mov_b64 exec, -1
    v_lshlrev_b32 v2, 2, v0
    s_mov_b64 exec, 15
    s_mov_b32 s30, 1048576
Llw_24:
    ds_read_b32 v3, v2 offset:62160
    s_waitcnt lgkmcnt(0)
    v_cmp_eq_u32 vcc, 0, v3
    s_sub_u32 s30, s30, 1
    s_cbranch_scc1 Llwd_25
    s_cbranch_vccz Llwd_25
    s_sleep 1
    s_branch Llw_24
Llwd_25:
    s_mov_b64 exec, -1
    s_mov_b32 m0, 4640
    s_nop 0
    buffer_load_dwordx4 v7, s[32:35], s53 offen offset:0 nt lds
    buffer_load_dwordx4 v7, s[32:35], s53 offen offset:1024 nt lds
    buffer_load_dwordx4 v7, s[32:35], s53 offen offset:2048 nt lds
    buffer_load_dwordx4 v7, s[32:35], s53 offen offset:3072 nt lds
    s_add_u32 s53, s53, 16384
    s_mov_b32 m0, 17568
    s_nop 0
    buffer_load_dwordx4 v7, s[32:35], s53 offen offset:0 nt lds
    buffer_load_dwordx4 v7, s[32:35], s53 offen offset:1024 nt lds
    buffer_load_dwordx4 v7, s[32:35], s53 offen offset:2048 nt lds
    buffer_load_dwordx4 v7, s[32:35], s53 offen offset:3072 nt lds
    s_add_u32 s53, s53, 16384
    s_mov_b32 m0, 30496
    s_nop 0
    buffer_load_dwordx4 v7, s[32:35], s53 offen offset:0 nt lds
    buffer_load_dwordx4 v7, s[32:35], s53 offen offset:1024 nt lds
    buffer_load_dwordx4 v7, s[32:35], s53 offen offset:2048 nt lds
    buffer_load_dwordx4 v7, s[32:35], s53 offen offset:3072 nt lds
    s_add_u32 s53, s53, 16384
    s_mov_b32 m0, 43424
    s_nop 0
    buffer_load_dwordx4 v7, s[32:35], s53 offen offset:0 nt lds
    buffer_load_dwordx4 v7, s[32:35], s53 offen offset:1024 nt lds
    buffer_load_dwordx4 v7, s[32:35], s53 offen offset:2048 nt lds
    buffer_load_dwordx4 v7, s[32:35], s53 offen offset:3072 nt lds
    s_add_u32 s53, s53, 16384
    s_branch L_b2
L_a2m:
    s_and_b32 s52, s2, 7
    s_lshr_b32 s53, s2, 3
    s_mul_i32 s54, s28, 328704
    s_mul_i32 s55, s52, 642
    s_mul_i32 s56, s53, 60
    s_add_u32 s55, s55, s56
    s_and_b32 s60, s55, 15
    s_cmp_eq_u32 s53, 10
    s_cselect_b32 s61, 57, 75
    s_add_u32 s60, s60, s61
    s_lshr_b32 s60, s60, 4
    s_and_b32 s55, s55, -16
    s_add_u32 s54, s54, s55
    s_add_u32 s55, s55, 1309680
    s_mul_i32 s56, s28, 5120
    s_add_u32 s56, s56, 80
    s_add_u32 s57, s56, 20560
    s_add_u32 s58, s56, 4096
    s_add_u32 s59, s57, 4096
    v_mov_b32 v10, 0x80000000
    v_add_u32 v3, 0, v0
    v_mul_u32_u24 v2, 205, v3
    v_lshrrev_b32 v2, 10, v2
    v_mul_u32_u24 v9, 5, v2
    v_sub_u32 v3, v3, v9
    v_cmp_gt_u32 vcc, s60, v3
    v_mul_u32_u24 v2, 5056, v2
    v_lshl_add_u32 v2, v0, 4, v2
    v_cndmask_b32 v4, v10, v2, vcc
    v_add_u32 v3, 64, v0
    v_mul_u32_u24 v2, 205, v3
    v_lshrrev_b32 v2, 10, v2
    v_mul_u32_u24 v9, 5, v2
    v_sub_u32 v3, v3, v9
    v_cmp_gt_u32 vcc, s60, v3
    v_mul_u32_u24 v2, 5056, v2
    v_lshl_add_u32 v2, v0, 4, v2
    v_cndmask_b32 v5, v10, v2, vcc
    v_add_u32 v3, 128, v0
    v_mul_u32_u24 v2, 205, v3
    v_lshrrev_b32 v2, 10, v2
    v_mul_u32_u24 v9, 5, v2
    v_sub_u32 v3, v3, v9
    v_cmp_gt_u32 vcc, s60, v3
    v_mul_u32_u24 v2, 5056, v2
    v_lshl_add_u32 v2, v0, 4, v2
    v_cndmask_b32 v6, v10, v2, vcc
    v_add_u32 v3, 192, v0
    v_mul_u32_u24 v2, 205, v3
    v_lshrrev_b32 v2, 10, v2
    v_mul_u32_u24 v9, 5, v2
    v_sub_u32 v3, v3, v9
    v_cmp_gt_u32 vcc, s60, v3
    v_mul_u32_u24 v2, 5056, v2
    v_lshl_add_u32 v2, v0, 4, v2
    v_cndmask_b32 v7, v10, v2, vcc
    v_add_u32 v3, 256, v0
    v_mul_u32_u24 v2, 205, v3
    v_lshrrev_b32 v2, 10, v2
    v_mul_u32_u24 v9, 5, v2
    v_sub_u32 v3, v3, v9
    v_cmp_gt_u32 vcc, s60, v3
    v_mul_u32_u24 v2, 5056, v2
    v_lshl_add_u32 v2, v0, 4, v2
    v_add_u32 v2, 4096, v2
    v_cndmask_b32 v8, v10, v2, vcc
    s_mov_b32 s32, s6
    s_mov_b32 s33, s7
    s_mov_b32 s34, 1314816
    s_mov_b32 s35, 0x20000
    s_mov_b32 s36, s8
    s_mov_b32 s37, s9
    s_mov_b32 s38, 1314816
    s_mov_b32 s39, 0x20000
    v_lshlrev_b32 v2, 2, v0
    s_mov_b64 exec, 15
    s_mov_b32 s30, 1048576
Llw_26:
    ds_read_b32 v3, v2 offset:62160
    s_waitcnt lgkmcnt(0)
    v_cmp_eq_u32 vcc, 0, v3
    s_sub_u32 s30, s30, 1
    s_cbranch_scc1 Llwd_27
    s_cbranch_vccz Llwd_27
    s_sleep 1
    s_branch Llw_26
Llwd_27:
    s_mov_b64 exec, -1
    s_mov_b32 m0, s56
    s_nop 0
    buffer_load_dwordx4 v4, s[32:35], s54 offen offset:0  lds
    buffer_load_dwordx4 v5, s[32:35], s54 offen offset:1024  lds
    buffer_load_dwordx4 v6, s[32:35], s54 offen offset:2048  lds
    buffer_load_dwordx4 v7, s[32:35], s54 offen offset:3072  lds
    s_mov_b32 m0, s58
    s_nop 0
    buffer_load_dwordx4 v8, s[32:35], s54 offen  lds
    s_mov_b64 exec, 31
    s_mov_b32 m0, 0
    s_nop 0
    buffer_load_dwordx4 v4, s[32:35], s55 offen  lds
    s_mov_b64 exec, -1
    s_mov_b32 m0, s57
    s_nop 0
    buffer_load_dwordx4 v4, s[36:39], s54 offen offset:0  lds
    buffer_load_dwordx4 v5, s[36:39], s54 offen offset:1024  lds
    buffer_load_dwordx4 v6, s[36:39], s54 offen offset:2048  lds
    buffer_load_dwordx4 v7, s[36:39], s54 offen offset:3072  lds
    s_mov_b32 m0, s59
    s_nop 0
    buffer_load_dwordx4 v8, s[36:39], s54 offen  lds
    s_mov_b64 exec, 31
    s_mov_b32 m0, 20560
    s_nop 0
    buffer_load_dwordx4 v4, s[36:39], s55 offen  lds
    s_mov_b64 exec, -1
L_a2:
    s_and_b32 s52, s2, 7
    s_lshr_b32 s53, s2, 3
    s_lshl_b32 s54, s53, 3
    s_add_u32 s54, s54, s28
    s_lshr_b32 s55, s54, 2
    s_lshl_b32 s55, s55, 3
    s_add_u32 s55, s55, s52
    s_lshl_b32 s55, s55, 14
    s_and_b32 s56, s54, 3
    s_lshl_b32 s56, s56, 12
    s_add_u32 s60, s55, s56
    s_lshl_b32 s55, s54, 2
    s_lshr_b32 s56, s54, 2
    s_sub_u32 s54, s55, s56
    s_mul_i32 s55, s54, 3277
    s_lshr_b32 s55, s55, 16
    s_mul_i32 s55, s55, 20
    s_sub_u32 s55, s54, s55
    s_lshr_b32 s58, 0xff800, s55
    s_cmp_eq_u32 s54, 319
    s_cselect_b32 s58, 3, s58
    s_cmp_eq_u32 s52, 0
    s_cselect_b32 s58, 0, s58
    s_lshl_b32 s56, s52, 1
    s_mul_i32 s57, s53, 60
    s_add_u32 s56, s56, s57
    s_and_b32 s56, s56, 15
    s_sub_u32 s56, s56, s57
    s_lshl_b32 s57, s54, 1
    s_add_u32 s76, s56, s57
    s_bitcmp1_b32 s58, 0
    s_cselect_b32 s57, 0, 80
    s_cselect_b32 s77, 80, 0
    s_cselect_b32 s55, 15, 0
    s_xor_b32 s58, s58, s55
    s_add_u32 s57, s57, s76
    s_add_u32 s77, s77, s76
    s_cmp_eq_u32 s54, 0
    s_cselect_b32 s59, 0.5, 1.0
    s_cmp_eq_u32 s54, 319
    s_cselect_b32 s68, 0.5, 1.0
    v_and_b32 v2, 15, v0
    v_lshrrev_b32 v3, 4, v0
    v_lshl_add_u32 v4, v3, 6, v2
    v_bfe_u32 v5, v0, 2, 2
    s_and_b32 s56, s28, 3
    v_xor_b32 v5, s56, v5
    v_lshlrev_b32 v5, 4, v5
    v_lshl_add_u32 v14, v4, 6, v5
    s_lshr_b32 s56, s28, 2
    s_lshl_b32 s56, s56, 14
    s_add_u32 s56, s56, 86144
    v_add_u32 v14, s56, v14
    v_and_b32 v5, 3, v0
    v_xor_b32 v5, v5, v3
    v_lshlrev_b32 v5, 4, v5
    v_lshrrev_b32 v15, 2, v0
    v_lshl_add_u32 v15, v15, 6, v5
    v_lshlrev_b32 v6, 4, v0
    v_mul_u32_u24 v5, 80, v4
    v_add_u32 v7, s57, v5
    v_add_u32 v8, s77, v5
    v_bfe_u32 v5, v0, 1, 2
    s_and_b32 s65, s28, 3
    v_xor_b32 v5, s65, v5
    v_lshlrev_b32 v5, 4, v5
    v_lshl_add_u32 v9, v4, 6, v5
    s_add_u32 s56, s56, 32768
    v_add_u32 v9, s56, v9
    s_lshl_b32 s55, s28, 12
    s_add_u32 s56, s55, 86144
    v_add_u32 v15, s56, v15
    s_add_u32 s55, s55, 118912
    v_lshrrev_b32 v4, 2, v0
    v_bfe_u32 v5, v0, 3, 2
    v_xor_b32 v5, v5, v0
    v_and_b32 v5, 3, v5
    v_lshlrev_b32 v5, 4, v5
    v_lshl_add_u32 v10, v4, 6, v5
    v_add_u32 v10, s55, v10
    v_mul_u32_u24 v11, 11264, v4
    v_and_b32 v5, 3, v0
    v_lshl_add_u32 v11, v5, 4, v11
    s_mul_i32 s61, s65, 720896
    s_lshl_b32 s55, s53, 1
    s_lshr_b32 s56, s28, 2
    s_add_u32 s55, s55, s56
    s_lshl_b32 s55, s55, 6
    s_add_u32 s61, s61, s55
    s_mul_i32 s55, s52, 1408
    s_add_u32 s61, s61, s55
    s_and_b32 s70, s28, 4
    s_lshl_b32 s70, s70, 2
    v_cvt_f32_u32 v12, v2
    v_lshlrev_b32 v3, 2, v3
    v_cvt_f32_u32 v13, v3
    v_mul_f32 v2, 0x3d800000, v12
    v_mul_f32 v3, 0x3b800000, v12
    v_add_f32 v4, 0x00000000, v13
    v_mul_f32 v5, v4, v2
    v_mul_f32 v4, v4, v3
    v_cos_f32 v64, v5
    v_sin_f32 v65, v5
    v_cos_f32 v24, v4
    v_sin_f32 v28, v4
    v_cvt_pk_bf16_f32 v16, v64, v65
    v_cvt_pk_bf16_f32 v20, -v65, v64
    v_add_f32 v4, 0x3f800000, v13
    v_mul_f32 v5, v4, v2
    v_mul_f32 v4, v4, v3
    v_cos_f32 v64, v5
    v_sin_f32 v65, v5
    v_cos_f32 v25, v4
    v_sin_f32 v29, v4
    v_cvt_pk_bf16_f32 v17, v64, v65
    v_cvt_pk_bf16_f32 v21, -v65, v64
    v_add_f32 v4, 0x40000000, v13
    v_mul_f32 v5, v4, v2
    v_mul_f32 v4, v4, v3
    v_cos_f32 v64, v5
    v_sin_f32 v65, v5
    v_cos_f32 v26, v4
    v_sin_f32 v30, v4
    v_cvt_pk_bf16_f32 v18, v64, v65
    v_cvt_pk_bf16_f32 v22, -v65, v64
    v_add_f32 v4, 0x40400000, v13
    v_mul_f32 v5, v4, v2
    v_mul_f32 v4, v4, v3
    v_cos_f32 v64, v5
    v_sin_f32 v65, v5
    v_cos_f32 v27, v4
    v_sin_f32 v31, v4
    v_cvt_pk_bf16_f32 v19, v64, v65
    v_cvt_pk_bf16_f32 v23, -v65, v64
    v_mul_f32 v96, 0x35cccccd, v24
    v_mul_f32 v136, 0x35cccccd, v28
    v_mul_f32 v97, 0x35cccccd, v25
    v_mul_f32 v137, 0x35cccccd, v29
    v_mul_f32 v98, 0x35cccccd, v26
    v_mul_f32 v138, 0x35cccccd, v30
    v_mul_f32 v99, 0x35cccccd, v27
    v_mul_f32 v139, 0x35cccccd, v31
    s_mov_b32 s32, s26
    s_mov_b32 s33, s27
    s_mov_b32 s34, 2883584
    s_mov_b32 s35, 0x20000
    s_add_u32 s40, s26, 6815744
    s_addc_u32 s41, s27, 0
    s_mov_b32 s42, 2883584
    s_mov_b32 s43, 0x20000
    s_mov_b32 s36, 0x03020c0c
    s_mov_b32 s37, 0x01000c0c
    s_mov_b32 s38, 0x05040c0c
    s_mov_b32 s74, s60
    s_mov_b32 s77, s61
    s_cmp_ge_u32 s28, 4
    s_cbranch_scc1 Lnw_28
    s_waitcnt vmcnt(0)
    s_lshl_b32 s30, s65, 2
    s_add_u32 s30, s30, 62208
    v_mov_b32 v2, s30
    v_mov_b32 v3, 1
    s_mov_b64 exec, 1
    ds_write_b32 v2, v3
    s_mov_b64 exec, -1
Lnw_28:
    s_mov_b32 s75, 131072
    s_mov_b32 s44, 0x88888888
    s_mov_b32 s45, 0x88888888
    buffer_load_dwordx4 v[80:83], v6, s[32:35], s74 offen offset:0 sc1
    buffer_load_dwordx4 v[84:87], v6, s[32:35], s74 offen offset:1024 sc1
    buffer_load_dwordx4 v[88:91], v6, s[32:35], s74 offen offset:2048 sc1
    buffer_load_dwordx4 v[92:95], v6, s[32:35], s74 offen offset:3072 sc1
    v_lshlrev_b32 v2, 2, v0
    s_mov_b64 exec, 15
    s_mov_b32 s30, 1048576
Llw_32:
    ds_read_b32 v3, v2 offset:62208
    s_waitcnt lgkmcnt(0)
    v_cmp_eq_u32 vcc, 0, v3
    s_sub_u32 s30, s30, 1
    s_cbranch_scc1 Llwd_33
    s_cbranch_vccz Llwd_33
    s_sleep 1
    s_branch Llw_32
Llwd_33:
    s_mov_b64 exec, -1
    v_and_b32 v4, -8, v7
    ds_read_b64 v[100:101], v4 offset:0
    ds_read_b64 v[102:103], v4 offset:8
    ds_read_b64 v[104:105], v4 offset:1280
    ds_read_b64 v[106:107], v4 offset:1288
    ds_read_b64 v[108:109], v4 offset:2560
    ds_read_b64 v[110:111], v4 offset:2568
    ds_read_b64 v[112:113], v4 offset:3840
    ds_read_b64 v[114:115], v4 offset:3848
    ds_read_b64 v[116:117], v4 offset:20560
    ds_read_b64 v[118:119], v4 offset:20568
    ds_read_b64 v[120:121], v4 offset:21840
    ds_read_b64 v[122:123], v4 offset:21848
    ds_read_b64 v[124:125], v4 offset:23120
    ds_read_b64 v[126:127], v4 offset:23128
    ds_read_b64 v[128:129], v4 offset:24400
    ds_read_b64 v[130:131], v4 offset:24408
    s_bitcmp1_b32 s76, 1
    s_cselect_b32 s66, s36, s37
    s_cselect_b32 s67, s38, s36
    s_bitcmp1_b32 s76, 2
    s_cbranch_scc1 Lwv_34
    s_waitcnt lgkmcnt(15)
    v_perm_b32 v32, v101, v100, s66
    v_perm_b32 v40, v101, v100, s67
    s_waitcnt lgkmcnt(14)
    v_perm_b32 v48, v102, v101, s66
    v_perm_b32 v56, v102, v101, s67
    s_waitcnt lgkmcnt(13)
    v_perm_b32 v33, v105, v104, s66
    v_perm_b32 v41, v105, v104, s67
    s_waitcnt lgkmcnt(12)
    v_perm_b32 v49, v106, v105, s66
    v_perm_b32 v57, v106, v105, s67
    s_waitcnt lgkmcnt(11)
    v_perm_b32 v34, v109, v108, s66
    v_perm_b32 v42, v109, v108, s67
    s_waitcnt lgkmcnt(10)
    v_perm_b32 v50, v110, v109, s66
    v_perm_b32 v58, v110, v109, s67
    s_waitcnt lgkmcnt(9)
    v_perm_b32 v35, v113, v112, s66
    v_perm_b32 v43, v113, v112, s67
    s_waitcnt lgkmcnt(8)
    v_perm_b32 v51, v114, v113, s66
    v_perm_b32 v59, v114, v113, s67
    s_waitcnt lgkmcnt(7)
    v_perm_b32 v36, v117, v116, s66
    v_perm_b32 v44, v117, v116, s67
    s_waitcnt lgkmcnt(6)
    v_perm_b32 v52, v118, v117, s66
    v_perm_b32 v60, v118, v117, s67
    s_waitcnt lgkmcnt(5)
    v_perm_b32 v37, v121, v120, s66
    v_perm_b32 v45, v121, v120, s67
    s_waitcnt lgkmcnt(4)
    v_perm_b32 v53, v122, v121, s66
    v_perm_b32 v61, v122, v121, s67
    s_waitcnt lgkmcnt(3)
    v_perm_b32 v38, v125, v124, s66
    v_perm_b32 v46, v125, v124, s67
    s_waitcnt lgkmcnt(2)
    v_perm_b32 v54, v126, v125, s66
    v_perm_b32 v62, v126, v125, s67
    s_waitcnt lgkmcnt(1)
    v_perm_b32 v39, v129, v128, s66
    v_perm_b32 v47, v129, v128, s67
    s_waitcnt lgkmcnt(0)
    v_perm_b32 v55, v130, v129, s66
    v_perm_b32 v63, v130, v129, s67
    s_branch Lwvd_35
Lwv_34:
    s_waitcnt lgkmcnt(14)
    v_perm_b32 v32, v102, v101, s66
    v_perm_b32 v40, v102, v101, s67
    v_perm_b32 v48, v103, v102, s66
    v_perm_b32 v56, v103, v102, s67
    s_waitcnt lgkmcnt(12)
    v_perm_b32 v33, v106, v105, s66
    v_perm_b32 v41, v106, v105, s67
    v_perm_b32 v49, v107, v106, s66
    v_perm_b32 v57, v107, v106, s67
    s_waitcnt lgkmcnt(10)
    v_perm_b32 v34, v110, v109, s66
    v_perm_b32 v42, v110, v109, s67
    v_perm_b32 v50, v111, v110, s66
    v_perm_b32 v58, v111, v110, s67
    s_waitcnt lgkmcnt(8)
    v_perm_b32 v35, v114, v113, s66
    v_perm_b32 v43, v114, v113, s67
    v_perm_b32 v51, v115, v114, s66
    v_perm_b32 v59, v115, v114, s67
    s_waitcnt lgkmcnt(6)
    v_perm_b32 v36, v118, v117, s66
    v_perm_b32 v44, v118, v117, s67
    v_perm_b32 v52, v119, v118, s66
    v_perm_b32 v60, v119, v118, s67
    s_waitcnt lgkmcnt(4)
    v_perm_b32 v37, v122, v121, s66
    v_perm_b32 v45, v122, v121, s67
    v_perm_b32 v53, v123, v122, s66
    v_perm_b32 v61, v123, v122, s67
    s_waitcnt lgkmcnt(2)
    v_perm_b32 v38, v126, v125, s66
    v_perm_b32 v46, v126, v125, s67
    v_perm_b32 v54, v127, v126, s66
    v_perm_b32 v62, v127, v126, s67
    s_waitcnt lgkmcnt(0)
    v_perm_b32 v39, v130, v129, s66
    v_perm_b32 v47, v130, v129, s67
    v_perm_b32 v55, v131, v130, s66
    v_perm_b32 v63, v131, v130, s67
Lwvd_35:
    s_bitcmp0_b32 s58, 1
    s_cbranch_scc1 Lnm_36
    ds_read_u16 v40, v8 offset:2
    ds_read_u16 v41, v8 offset:1282
    ds_read_u16 v42, v8 offset:2562
    ds_read_u16 v43, v8 offset:3842
    ds_read_u16 v44, v8 offset:20562
    ds_read_u16 v45, v8 offset:21842
    ds_read_u16 v46, v8 offset:23122
    ds_read_u16 v47, v8 offset:24402
    s_waitcnt lgkmcnt(7)
    v_lshlrev_b32 v40, 16, v40
    s_waitcnt lgkmcnt(6)
    v_lshlrev_b32 v41, 16, v41
    s_waitcnt lgkmcnt(5)
    v_lshlrev_b32 v42, 16, v42
    s_waitcnt lgkmcnt(4)
    v_lshlrev_b32 v43, 16, v43
    s_waitcnt lgkmcnt(3)
    v_lshlrev_b32 v44, 16, v44
    s_waitcnt lgkmcnt(2)
    v_lshlrev_b32 v45, 16, v45
    s_waitcnt lgkmcnt(1)
    v_lshlrev_b32 v46, 16, v46
    s_waitcnt lgkmcnt(0)
    v_lshlrev_b32 v47, 16, v47
Lnm_36:
    s_bitcmp0_b32 s58, 2
    s_cbranch_scc1 Lnm_37
    ds_read_u16 v48, v8 offset:4
    ds_read_u16 v49, v8 offset:1284
    ds_read_u16 v50, v8 offset:2564
    ds_read_u16 v51, v8 offset:3844
    ds_read_u16 v52, v8 offset:20564
    ds_read_u16 v53, v8 offset:21844
    ds_read_u16 v54, v8 offset:23124
    ds_read_u16 v55, v8 offset:24404
    s_waitcnt lgkmcnt(7)
    v_lshlrev_b32 v48, 16, v48
    s_waitcnt lgkmcnt(6)
    v_lshlrev_b32 v49, 16, v49
    s_waitcnt lgkmcnt(5)
    v_lshlrev_b32 v50, 16, v50
    s_waitcnt lgkmcnt(4)
    v_lshlrev_b32 v51, 16, v51
    s_waitcnt lgkmcnt(3)
    v_lshlrev_b32 v52, 16, v52
    s_waitcnt lgkmcnt(2)
    v_lshlrev_b32 v53, 16, v53
    s_waitcnt lgkmcnt(1)
    v_lshlrev_b32 v54, 16, v54
    s_waitcnt lgkmcnt(0)
    v_lshlrev_b32 v55, 16, v55
Lnm_37:
    s_bitcmp0_b32 s58, 3
    s_cbranch_scc1 Lnm_38
    ds_read_u16 v56, v8 offset:6
    ds_read_u16 v57, v8 offset:1286
    ds_read_u16 v58, v8 offset:2566
    ds_read_u16 v59, v8 offset:3846
    ds_read_u16 v60, v8 offset:20566
    ds_read_u16 v61, v8 offset:21846
    ds_read_u16 v62, v8 offset:23126
    ds_read_u16 v63, v8 offset:24406
    s_waitcnt lgkmcnt(7)
    v_lshlrev_b32 v56, 16, v56
    s_waitcnt lgkmcnt(6)
    v_lshlrev_b32 v57, 16, v57
    s_waitcnt lgkmcnt(5)
    v_lshlrev_b32 v58, 16, v58
    s_waitcnt lgkmcnt(4)
    v_lshlrev_b32 v59, 16, v59
    s_waitcnt lgkmcnt(3)
    v_lshlrev_b32 v60, 16, v60
    s_waitcnt lgkmcnt(2)
    v_lshlrev_b32 v61, 16, v61
    s_waitcnt lgkmcnt(1)
    v_lshlrev_b32 v62, 16, v62
    s_waitcnt lgkmcnt(0)
    v_lshlrev_b32 v63, 16, v63
Lnm_38:
    v_mul_f32 v32, s59, v32
    v_mul_f32 v33, s59, v33
    v_mul_f32 v34, s59, v34
    v_mul_f32 v35, s59, v35
    v_mul_f32 v36, s59, v36
    v_mul_f32 v37, s59, v37
    v_mul_f32 v38, s59, v38
    v_mul_f32 v39, s59, v39
    v_mul_f32 v40, s68, v40
    v_mul_f32 v41, s68, v41
    v_mul_f32 v42, s68, v42
    v_mul_f32 v43, s68, v43
    v_mul_f32 v44, s68, v44
    v_mul_f32 v45, s68, v45
    v_mul_f32 v46, s68, v46
    v_mul_f32 v47, s68, v47
    s_mov_b32 s75, 131072
    s_mov_b64 s[90:91], -1
    s_mov_b64 s[92:93], -1
    s_mov_b64 s[94:95], -1
    s_mov_b64 s[96:97], -1
    s_branch Llti_31
Llt_29:
    s_mov_b64 exec, s[90:91]
    s_cbranch_execz Lls_39
    buffer_load_dwordx4 v[80:83], v6, s[32:35], s74 offen offset:0 sc1
Lls_39:
    s_mov_b64 exec, s[92:93]
    s_cbranch_execz Lls_40
    buffer_load_dwordx4 v[84:87], v6, s[32:35], s74 offen offset:1024 sc1
Lls_40:
    s_mov_b64 exec, s[94:95]
    s_cbranch_execz Lls_41
    buffer_load_dwordx4 v[88:91], v6, s[32:35], s74 offen offset:2048 sc1
Lls_41:
    s_mov_b64 exec, s[96:97]
    s_cbranch_execz Lls_42
    buffer_load_dwordx4 v[92:95], v6, s[32:35], s74 offen offset:3072 sc1
Lls_42:
Llti_31:
    s_mov_b64 exec, s[44:45]
    s_mov_b64 s[46:47], 0
    s_waitcnt vmcnt(0)
    v_cmp_ne_u32 vcc, s29, v83
    s_nop 1
    s_and_b64 s[90:91], s[90:91], vcc
    s_lshr_b64 vcc, s[90:91], 1
    s_or_b64 s[90:91], s[90:91], vcc
    s_lshr_b64 vcc, s[90:91], 2
    s_or_b64 s[90:91], s[90:91], vcc
    s_or_b64 s[46:47], s[46:47], s[90:91]
    v_cmp_ne_u32 vcc, s29, v87
    s_nop 1
    s_and_b64 s[92:93], s[92:93], vcc
    s_lshr_b64 vcc, s[92:93], 1
    s_or_b64 s[92:93], s[92:93], vcc
    s_lshr_b64 vcc, s[92:93], 2
    s_or_b64 s[92:93], s[92:93], vcc
    s_or_b64 s[46:47], s[46:47], s[92:93]
    v_cmp_ne_u32 vcc, s29, v91
    s_nop 1
    s_and_b64 s[94:95], s[94:95], vcc
    s_lshr_b64 vcc, s[94:95], 1
    s_or_b64 s[94:95], s[94:95], vcc
    s_lshr_b64 vcc, s[94:95], 2
    s_or_b64 s[94:95], s[94:95], vcc
    s_or_b64 s[46:47], s[46:47], s[94:95]
    v_cmp_ne_u32 vcc, s29, v95
    s_nop 1
    s_and_b64 s[96:97], s[96:97], vcc
    s_lshr_b64 vcc, s[96:97], 1
    s_or_b64 s[96:97], s[96:97], vcc
    s_lshr_b64 vcc, s[96:97], 2
    s_or_b64 s[96:97], s[96:97], vcc
    s_or_b64 s[46:47], s[46:47], s[96:97]
    s_cbranch_scc0 Lltd_30
    s_sub_u32 s75, s75, 1
    s_cbranch_scc1 Lltd_30
    s_sleep 2
    s_branch Llt_29
Lltd_30:
    s_mov_b64 exec, -1
    s_cmp_ge_u32 s28, 3
    s_cbranch_scc1 Lnq_43
    s_mov_b32 s36, s10
    s_mov_b32 s37, s11
    s_mov_b32 s38, 2621440
    s_mov_b32 s39, 0x20000
    s_mov_b32 s69, 5120
    buffer_load_dwordx2 v[240:241], v239, s[36:39], 0 offen offset:0 nt
    buffer_load_dwordx2 v[242:243], v239, s[36:39], 0 offen offset:1280 nt
    buffer_load_dwordx2 v[244:245], v239, s[36:39], 0 offen offset:2560 nt
    buffer_load_dwordx2 v[246:247], v239, s[36:39], 0 offen offset:3840 nt
    buffer_load_dwordx2 v[248:249], v239, s[36:39], s69 offen offset:0 nt
    buffer_load_dwordx2 v[250:251], v239, s[36:39], s69 offen offset:1280 nt
    buffer_load_dwordx2 v[252:253], v239, s[36:39], s69 offen offset:2560 nt
    buffer_load_dwordx2 v[254:255], v239, s[36:39], s69 offen offset:3840 nt
Lnq_43:
    ds_write_b128 v15, v[80:83] offset:0
    ds_write_b128 v15, v[84:87] offset:1024
    ds_write_b128 v15, v[88:91] offset:2048
    ds_write_b128 v15, v[92:95] offset:3072
    s_mov_b32 s61, s77
    s_add_u32 s62, s77, 180224
    s_add_u32 s63, s77, 360448
    s_add_u32 s64, s77, 540672
    s_lshl2_add_u32 s30, s28, 62432
    s_mov_b64 exec, 15
    v_mov_b32 v2, s30
    v_lshl_add_u32 v4, v0, 2, s70
    ds_write_b32 v2, v2
    s_mov_b32 s30, 1048576
Llj_44:
    ds_read_b32 v5, v4 offset:62432
    s_sub_u32 s30, s30, 1
    s_cbranch_scc1 Lljd_45
    s_waitcnt lgkmcnt(0)
    v_cmp_eq_u32 vcc, 0, v5
    s_nop 1
    s_cbranch_vccnz Llj_44
Lljd_45:
    s_mov_b64 exec, -1
    ds_read_b128 v[64:67], v14 offset:0
    ds_read_b128 v[68:71], v14 offset:1024
    ds_read_b128 v[72:75], v14 offset:2048
    ds_read_b128 v[76:79], v14 offset:3072
    s_waitcnt lgkmcnt(2)
    v_swap_b32 v65, v68
    s_waitcnt lgkmcnt(1)
    v_swap_b32 v66, v72
    s_waitcnt lgkmcnt(0)
    v_swap_b32 v67, v76
    v_swap_b32 v70, v73
    v_swap_b32 v71, v77
    v_mfma_f32_16x16x32_bf16 v[100:103], v[64:67], v[16:19], 0
    v_mfma_f32_16x16x32_bf16 v[104:107], v[64:67], v[20:23], 0
    v_swap_b32 v75, v78
    v_mfma_f32_16x16x32_bf16 v[108:111], v[68:71], v[16:19], 0
    v_mfma_f32_16x16x32_bf16 v[112:115], v[68:71], v[20:23], 0
    v_mfma_f32_16x16x32_bf16 v[116:119], v[72:75], v[16:19], 0
    v_mfma_f32_16x16x32_bf16 v[120:123], v[72:75], v[20:23], 0
    v_mfma_f32_16x16x32_bf16 v[124:127], v[76:79], v[16:19], 0
    v_mfma_f32_16x16x32_bf16 v[128:131], v[76:79], v[20:23], 0
    s_lshl_b32 s76, s52, 7
    s_add_u32 s76, s76, 65536
    v_pk_mul_f32 v[80:81], v[100:101], v[136:137]
    v_pk_mul_f32 v[82:83], v[102:103], v[138:139]
    v_pk_mul_f32 v[84:85], v[108:109], v[136:137]
    v_pk_mul_f32 v[86:87], v[110:111], v[138:139]
    v_pk_mul_f32 v[100:101], v[100:101], v[96:97]
    v_pk_mul_f32 v[102:103], v[102:103], v[98:99]
    v_pk_mul_f32 v[108:109], v[108:109], v[96:97]
    v_pk_mul_f32 v[110:111], v[110:111], v[98:99]
    v_pk_fma_f32 v[100:101], v[104:105], v[136:137], v[100:101]
    v_pk_fma_f32 v[102:103], v[106:107], v[138:139], v[102:103]
    v_pk_fma_f32 v[108:109], v[112:113], v[136:137], v[108:109]
    v_pk_fma_f32 v[110:111], v[114:115], v[138:139], v[110:111]
    v_pk_fma_f32 v[104:105], v[104:105], v[96:97], v[80:81] neg_lo:[0,0,1] neg_hi:[0,0,1]
    v_pk_fma_f32 v[106:107], v[106:107], v[98:99], v[82:83] neg_lo:[0,0,1] neg_hi:[0,0,1]
    v_pk_fma_f32 v[112:113], v[112:113], v[96:97], v[84:85] neg_lo:[0,0,1] neg_hi:[0,0,1]
    v_pk_fma_f32 v[114:115], v[114:115], v[98:99], v[86:87] neg_lo:[0,0,1] neg_hi:[0,0,1]
    v_pk_mul_f32 v[88:89], v[116:117], v[136:137]
    v_pk_mul_f32 v[90:91], v[118:119], v[138:139]
    v_pk_mul_f32 v[92:93], v[124:125], v[136:137]
    v_pk_mul_f32 v[94:95], v[126:127], v[138:139]
    v_pk_mul_f32 v[116:117], v[116:117], v[96:97]
    v_pk_mul_f32 v[118:119], v[118:119], v[98:99]
    v_pk_mul_f32 v[124:125], v[124:125], v[96:97]
    v_pk_mul_f32 v[126:127], v[126:127], v[98:99]
    v_pk_fma_f32 v[116:117], v[120:121], v[136:137], v[116:117]
    v_pk_fma_f32 v[118:119], v[122:123], v[138:139], v[118:119]
    v_pk_fma_f32 v[124:125], v[128:129], v[136:137], v[124:125]
    v_pk_fma_f32 v[126:127], v[130:131], v[138:139], v[126:127]
    v_pk_fma_f32 v[120:121], v[120:121], v[96:97], v[88:89] neg_lo:[0,0,1] neg_hi:[0,0,1]
    v_pk_fma_f32 v[122:123], v[122:123], v[98:99], v[90:91] neg_lo:[0,0,1] neg_hi:[0,0,1]
    v_pk_fma_f32 v[128:129], v[128:129], v[96:97], v[92:93] neg_lo:[0,0,1] neg_hi:[0,0,1]
    v_pk_fma_f32 v[130:131], v[130:131], v[98:99], v[94:95] neg_lo:[0,0,1] neg_hi:[0,0,1]
    v_cvt_pk_bf16_f32 v64, v100, v104
    v_cvt_pk_bf16_f32 v65, v101, v105
    v_cvt_pk_bf16_f32 v66, v102, v106
    v_cvt_pk_bf16_f32 v67, v103, v107
    v_cvt_pk_bf16_f32 v68, v108, v112
    v_cvt_pk_bf16_f32 v69, v109, v113
    v_mfma_f32_16x16x32_bf16 v[100:103], v[16:19], v[64:67], 0
    v_cvt_pk_bf16_f32 v70, v110, v114
    v_mfma_f32_16x16x32_bf16 v[104:107], v[20:23], v[64:67], 0
    v_cvt_pk_bf16_f32 v71, v111, v115
    v_cvt_pk_bf16_f32 v72, v116, v120
    v_cvt_pk_bf16_f32 v73, v117, v121
    v_mfma_f32_16x16x32_bf16 v[108:111], v[16:19], v[68:71], 0
    v_cvt_pk_bf16_f32 v74, v118, v122
    v_mfma_f32_16x16x32_bf16 v[112:115], v[20:23], v[68:71], 0
    v_cvt_pk_bf16_f32 v75, v119, v123
    v_cvt_pk_bf16_f32 v76, v124, v128
    v_cvt_pk_bf16_f32 v77, v125, v129
    v_mfma_f32_16x16x32_bf16 v[116:119], v[16:19], v[72:75], 0
    v_cvt_pk_bf16_f32 v78, v126, v130
    v_mfma_f32_16x16x32_bf16 v[120:123], v[20:23], v[72:75], 0
    v_cvt_pk_bf16_f32 v79, v127, v131
    s_nop 1
    v_mfma_f32_16x16x32_bf16 v[124:127], v[16:19], v[76:79], 0
    v_mfma_f32_16x16x32_bf16 v[128:131], v[20:23], v[76:79], 0
    v_mov_b32 v132, 62080
    v_mov_b32 v133, 1
    s_mov_b64 exec, 1
    ds_add_rtn_u32 v134, v132, v133
    s_waitcnt lgkmcnt(0)
    v_cmp_ne_u32 vcc, 7, v134
    s_mov_b32 s75, 0
    s_nop 0
    s_cbranch_vccnz Lhb_46
    s_mov_b32 s75, 1
    v_mov_b32 v134, 1
    buffer_atomic_add v134, off, s[48:51], s76 sc0 sc1
Lhb_46:
    s_mov_b64 exec, -1
    s_nop 7
    v_pk_mul_f32 v[80:81], v[100:101], v[36:37]
    v_pk_mul_f32 v[82:83], v[102:103], v[38:39]
    v_pk_mul_f32 v[84:85], v[108:109], v[44:45]
    v_pk_mul_f32 v[86:87], v[110:111], v[46:47]
    v_pk_mul_f32 v[100:101], v[100:101], v[32:33]
    v_pk_mul_f32 v[102:103], v[102:103], v[34:35]
    v_pk_mul_f32 v[108:109], v[108:109], v[40:41]
    v_pk_mul_f32 v[110:111], v[110:111], v[42:43]
    v_pk_fma_f32 v[100:101], v[104:105], v[36:37], v[100:101] neg_lo:[1,0,0] neg_hi:[1,0,0]
    v_pk_fma_f32 v[102:103], v[106:107], v[38:39], v[102:103] neg_lo:[1,0,0] neg_hi:[1,0,0]
    v_pk_fma_f32 v[108:109], v[112:113], v[44:45], v[108:109] neg_lo:[1,0,0] neg_hi:[1,0,0]
    v_pk_fma_f32 v[110:111], v[114:115], v[46:47], v[110:111] neg_lo:[1,0,0] neg_hi:[1,0,0]
    v_pk_fma_f32 v[104:105], v[104:105], v[32:33], v[80:81]
    v_pk_fma_f32 v[106:107], v[106:107], v[34:35], v[82:83]
    v_pk_fma_f32 v[112:113], v[112:113], v[40:41], v[84:85]
    v_pk_fma_f32 v[114:115], v[114:115], v[42:43], v[86:87]
    v_pk_mul_f32 v[88:89], v[116:117], v[52:53]
    v_pk_mul_f32 v[90:91], v[118:119], v[54:55]
    v_pk_mul_f32 v[92:93], v[124:125], v[60:61]
    v_pk_mul_f32 v[94:95], v[126:127], v[62:63]
    v_pk_mul_f32 v[116:117], v[116:117], v[48:49]
    v_pk_mul_f32 v[118:119], v[118:119], v[50:51]
    v_pk_mul_f32 v[124:125], v[124:125], v[56:57]
    v_pk_mul_f32 v[126:127], v[126:127], v[58:59]
    v_pk_fma_f32 v[116:117], v[120:121], v[52:53], v[116:117] neg_lo:[1,0,0] neg_hi:[1,0,0]
    v_pk_fma_f32 v[118:119], v[122:123], v[54:55], v[118:119] neg_lo:[1,0,0] neg_hi:[1,0,0]
    v_pk_fma_f32 v[124:125], v[128:129], v[60:61], v[124:125] neg_lo:[1,0,0] neg_hi:[1,0,0]
    v_pk_fma_f32 v[126:127], v[130:131], v[62:63], v[126:127] neg_lo:[1,0,0] neg_hi:[1,0,0]
    v_pk_fma_f32 v[120:121], v[120:121], v[48:49], v[88:89]
    v_pk_fma_f32 v[122:123], v[122:123], v[50:51], v[90:91]
    v_pk_fma_f32 v[128:129], v[128:129], v[56:57], v[92:93]
    v_pk_fma_f32 v[130:131], v[130:131], v[58:59], v[94:95]
    v_cvt_pk_bf16_f32 v64, v104, v100
    v_cvt_pk_bf16_f32 v65, v105, v101
    v_cvt_pk_bf16_f32 v66, v106, v102
    v_cvt_pk_bf16_f32 v67, v107, v103
    v_cvt_pk_bf16_f32 v68, v112, v108
    v_cvt_pk_bf16_f32 v69, v113, v109
    v_mfma_f32_16x16x32_bf16 v[100:103], v[64:67], v[16:19], 0
    v_cvt_pk_bf16_f32 v70, v114, v110
    v_mfma_f32_16x16x32_bf16 v[104:107], v[64:67], v[20:23], 0
    v_cvt_pk_bf16_f32 v71, v115, v111
    v_cvt_pk_bf16_f32 v72, v120, v116
    v_cvt_pk_bf16_f32 v73, v121, v117
    v_mfma_f32_16x16x32_bf16 v[108:111], v[68:71], v[16:19], 0
    v_cvt_pk_bf16_f32 v74, v122, v118
    v_mfma_f32_16x16x32_bf16 v[112:115], v[68:71], v[20:23], 0
    v_cvt_pk_bf16_f32 v75, v123, v119
    v_cvt_pk_bf16_f32 v76, v128, v124
    v_cvt_pk_bf16_f32 v77, v129, v125
    v_mfma_f32_16x16x32_bf16 v[116:119], v[72:75], v[16:19], 0
    v_cvt_pk_bf16_f32 v78, v130, v126
    v_mfma_f32_16x16x32_bf16 v[120:123], v[72:75], v[20:23], 0
    v_cvt_pk_bf16_f32 v79, v131, v127
    s_nop 1
    v_mfma_f32_16x16x32_bf16 v[124:127], v[76:79], v[16:19], 0
    v_mfma_f32_16x16x32_bf16 v[128:131], v[76:79], v[20:23], 0
    v_pk_mul_f32 v[80:81], v[104:105], v[28:29]
    v_pk_mul_f32 v[82:83], v[106:107], v[30:31]
    v_pk_mul_f32 v[84:85], v[112:113], v[28:29]
    v_pk_mul_f32 v[86:87], v[114:115], v[30:31]
    v_pk_mul_f32 v[104:105], v[104:105], v[24:25]
    v_pk_mul_f32 v[106:107], v[106:107], v[26:27]
    v_pk_mul_f32 v[112:113], v[112:113], v[24:25]
    v_pk_mul_f32 v[114:115], v[114:115], v[26:27]
    v_pk_fma_f32 v[104:105], v[100:101], v[28:29], v[104:105] neg_lo:[1,0,0] neg_hi:[1,0,0]
    v_pk_fma_f32 v[106:107], v[102:103], v[30:31], v[106:107] neg_lo:[1,0,0] neg_hi:[1,0,0]
    v_pk_fma_f32 v[112:113], v[108:109], v[28:29], v[112:113] neg_lo:[1,0,0] neg_hi:[1,0,0]
    v_pk_fma_f32 v[114:115], v[110:111], v[30:31], v[114:115] neg_lo:[1,0,0] neg_hi:[1,0,0]
    v_pk_fma_f32 v[100:101], v[100:101], v[24:25], v[80:81]
    v_pk_fma_f32 v[102:103], v[102:103], v[26:27], v[82:83]
    v_pk_fma_f32 v[108:109], v[108:109], v[24:25], v[84:85]
    v_pk_fma_f32 v[110:111], v[110:111], v[26:27], v[86:87]
    v_pk_mul_f32 v[88:89], v[120:121], v[28:29]
    v_pk_mul_f32 v[90:91], v[122:123], v[30:31]
    v_pk_mul_f32 v[92:93], v[128:129], v[28:29]
    v_pk_mul_f32 v[94:95], v[130:131], v[30:31]
    v_pk_mul_f32 v[120:121], v[120:121], v[24:25]
    v_pk_mul_f32 v[122:123], v[122:123], v[26:27]
    v_pk_mul_f32 v[128:129], v[128:129], v[24:25]
    v_pk_mul_f32 v[130:131], v[130:131], v[26:27]
    v_pk_fma_f32 v[120:121], v[116:117], v[28:29], v[120:121] neg_lo:[1,0,0] neg_hi:[1,0,0]
    v_pk_fma_f32 v[122:123], v[118:119], v[30:31], v[122:123] neg_lo:[1,0,0] neg_hi:[1,0,0]
    v_pk_fma_f32 v[128:129], v[124:125], v[28:29], v[128:129] neg_lo:[1,0,0] neg_hi:[1,0,0]
    v_pk_fma_f32 v[130:131], v[126:127], v[30:31], v[130:131] neg_lo:[1,0,0] neg_hi:[1,0,0]
    v_pk_fma_f32 v[116:117], v[116:117], v[24:25], v[88:89]
    v_pk_fma_f32 v[118:119], v[118:119], v[26:27], v[90:91]
    v_pk_fma_f32 v[124:125], v[124:125], v[24:25], v[92:93]
    v_pk_fma_f32 v[126:127], v[126:127], v[26:27], v[94:95]
    v_cvt_pk_bf16_f32 v64, v100, v104
    v_cvt_pk_bf16_f32 v65, v101, v105
    v_cvt_pk_bf16_f32 v66, v102, v106
    v_cvt_pk_bf16_f32 v67, v103, v107
    v_cvt_pk_bf16_f32 v68, v108, v112
    v_cvt_pk_bf16_f32 v69, v109, v113
    v_mfma_f32_16x16x32_bf16 v[100:103], v[16:19], v[64:67], 0
    v_cvt_pk_bf16_f32 v70, v110, v114
    v_mfma_f32_16x16x32_bf16 v[104:107], v[20:23], v[64:67], 0
    v_cvt_pk_bf16_f32 v71, v111, v115
    v_cvt_pk_bf16_f32 v72, v116, v120
    v_cvt_pk_bf16_f32 v73, v117, v121
    v_mfma_f32_16x16x32_bf16 v[108:111], v[16:19], v[68:71], 0
    v_cvt_pk_bf16_f32 v74, v118, v122
    v_mfma_f32_16x16x32_bf16 v[112:115], v[20:23], v[68:71], 0
    v_cvt_pk_bf16_f32 v75, v119, v123
    v_cvt_pk_bf16_f32 v76, v124, v128
    v_cvt_pk_bf16_f32 v77, v125, v129
    v_mfma_f32_16x16x32_bf16 v[116:119], v[16:19], v[72:75], 0
    v_cvt_pk_bf16_f32 v78, v126, v130
    v_mfma_f32_16x16x32_bf16 v[120:123], v[20:23], v[72:75], 0
    v_cvt_pk_bf16_f32 v79, v127, v131
    s_nop 1
    v_mfma_f32_16x16x32_bf16 v[124:127], v[16:19], v[76:79], 0
    v_mfma_f32_16x16x32_bf16 v[128:131], v[20:23], v[76:79], 0
    v_cvt_pk_bf16_f32 v80, v104, v100
    v_cvt_pk_bf16_f32 v84, v105, v101
    v_cvt_pk_bf16_f32 v88, v106, v102
    v_cvt_pk_bf16_f32 v92, v107, v103
    v_cvt_pk_bf16_f32 v81, v112, v108
    v_cvt_pk_bf16_f32 v85, v113, v109
    v_cvt_pk_bf16_f32 v89, v114, v110
    v_cvt_pk_bf16_f32 v93, v115, v111
    v_cvt_pk_bf16_f32 v82, v120, v116
    v_cvt_pk_bf16_f32 v86, v121, v117
    v_cvt_pk_bf16_f32 v90, v122, v118
    v_cvt_pk_bf16_f32 v94, v123, v119
    v_cvt_pk_bf16_f32 v83, v128, v124
    v_cvt_pk_bf16_f32 v87, v129, v125
    v_cvt_pk_bf16_f32 v91, v130, v126
    v_cvt_pk_bf16_f32 v95, v131, v127
    ds_write_b128 v9, v[80:83] offset:0
    ds_write_b128 v9, v[84:87] offset:1024
    ds_write_b128 v9, v[88:91] offset:2048
    ds_write_b128 v9, v[92:95] offset:3072
    v_mov_b32 v12, s29
    s_cmp_eq_u32 s75, 0
    s_cbranch_scc1 Lhe_47
    v_mov_b32 v132, s29
    s_add_u32 s30, s76, 32768
    s_mov_b64 exec, 1
    s_waitcnt vmcnt(0)
    v_cmp_ne_u32 vcc, 10, v134
    s_nop 1
    s_cbranch_vccnz Lhe_47
    buffer_store_dword v132, off, s[48:51], s30 sc1
Lhe_47:
    s_mov_b64 exec, -1
    s_lshl2_add_u32 s30, s28, 62176
    s_mov_b64 exec, 15
    v_mov_b32 v2, s30
    v_lshl_add_u32 v4, v0, 2, s70
    ds_write_b32 v2, v2
    s_mov_b32 s30, 1048576
Llj_48:
    ds_read_b32 v5, v4 offset:62176
    s_sub_u32 s30, s30, 1
    s_cbranch_scc1 Lljd_49
    s_waitcnt lgkmcnt(0)
    v_cmp_eq_u32 vcc, 0, v5
    s_nop 1
    s_cbranch_vccnz Llj_48
Lljd_49:
    s_mov_b64 exec, -1
    ds_read_b128 v[80:83], v10 offset:0
    ds_read_b128 v[84:87], v10 offset:1024
    ds_read_b128 v[88:91], v10 offset:2048
    ds_read_b128 v[92:95], v10 offset:3072
    s_waitcnt lgkmcnt(3)
    v_cndmask_b32 v83, v83, v12, s[44:45]
    buffer_store_dwordx4 v[80:83], v11, s[40:43], s61 offen sc1
    s_waitcnt lgkmcnt(2)
    v_cndmask_b32 v87, v87, v12, s[44:45]
    buffer_store_dwordx4 v[84:87], v11, s[40:43], s62 offen sc1
    s_waitcnt lgkmcnt(1)
    v_cndmask_b32 v91, v91, v12, s[44:45]
    buffer_store_dwordx4 v[88:91], v11, s[40:43], s63 offen sc1
    s_waitcnt lgkmcnt(0)
    v_cndmask_b32 v95, v95, v12, s[44:45]
    buffer_store_dwordx4 v[92:95], v11, s[40:43], s64 offen sc1
    s_cmp_ge_u32 s28, 4
    s_cbranch_scc1 L_a3
    s_cmp_eq_u32 s28, 3
    s_cbranch_scc1 L_end3
    s_branch L_b3
L_q:
    v_lshlrev_b32 v2, 2, v0
    s_mov_b64 exec, 15
    s_mov_b32 s30, 1048576
Llw_50:
    ds_read_b32 v3, v2 offset:62016
    s_waitcnt lgkmcnt(0)
    v_cmp_eq_u32 vcc, 0, v3
    s_sub_u32 s30, s30, 1
    s_cbranch_scc1 Llwd_51
    s_cbranch_vccz Llwd_51
    s_sleep 2
    s_branch Llw_50
Llwd_51:
    s_mov_b64 exec, -1
    s_mov_b32 s40, s10
    s_mov_b32 s41, s11
    s_mov_b32 s42, 2621440
    s_mov_b32 s43, 0x20000
    s_mov_b32 s69, 5120
    s_mov_b64 exec, s[72:73]
    s_waitcnt vmcnt(13)
    buffer_load_dwordx2 v[240:241], v236, s[40:43], 0 offen offset:0 nt
    s_waitcnt vmcnt(13)
    buffer_load_dwordx2 v[242:243], v236, s[40:43], 0 offen offset:1280 nt
    s_waitcnt vmcnt(13)
    buffer_load_dwordx2 v[244:245], v236, s[40:43], 0 offen offset:2560 nt
    s_waitcnt vmcnt(13)
    buffer_load_dwordx2 v[246:247], v236, s[40:43], 0 offen offset:3840 nt
    s_waitcnt vmcnt(13)
    buffer_load_dwordx2 v[248:249], v236, s[40:43], s69 offen offset:0 nt
    s_waitcnt vmcnt(13)
    buffer_load_dwordx2 v[250:251], v236, s[40:43], s69 offen offset:1280 nt
    s_waitcnt vmcnt(13)
    buffer_load_dwordx2 v[252:253], v236, s[40:43], s69 offen offset:2560 nt
    s_waitcnt vmcnt(13)
    buffer_load_dwordx2 v[254:255], v236, s[40:43], s69 offen offset:3840 nt
    s_mov_b64 exec, -1
    s_branch L_b3
.p2align 6
L_b2:
    s_sub_u32 s52, s2, 88
    s_lshr_b32 s53, s52, 2
    s_lshl_b32 s53, s53, 4
    s_and_b32 s54, s52, 3
    s_add_u32 s53, s53, s54
    s_lshl_b32 s54, s28, 2
    s_add_u32 s53, s53, s54
    s_lshl_b32 s54, s53, 12
    s_lshl_b32 s55, s52, 14
    s_lshl_b32 s56, s28, 12
    s_add_u32 s67, s55, s56
    s_mul_i32 s57, s28, 12928
    v_lshlrev_b32 v2, 4, v0
    v_lshlrev_b32 v3, 6, v0
    s_lshl_b32 s58, s53, 1
    v_mov_b32 v6, s58
    s_mul_i32 s68, s52, 205
    s_lshr_b32 s68, s68, 11
    s_lshl_b32 s68, s68, 7
    s_add_u32 s68, s68, 66560
    s_lshr_b32 s66, s67, 2
    s_add_u32 s66, s66, 2621440
    s_add_u32 s36, s26, 3145728
    s_addc_u32 s37, s27, 0
    s_mov_b32 s38, 3276800
    s_mov_b32 s39, 0x20000
    s_mov_b32 s40, s20
    s_mov_b32 s41, s21
    s_mov_b32 s42, 1280
    s_mov_b32 s43, 0x20000
    buffer_load_ushort v14, v6, s[40:43], 0 offen
    v_mov_b32 v13, v2
    v_and_b32 v4, 15, v0
    v_lshrrev_b32 v5, 4, v0
    v_add_u32 v2, s57, v2
    v_mov_b32 v24, 0
    v_mov_b32 v25, 0
    v_mov_b32 v26, 0
    v_mov_b32 v27, 0
    v_lshlrev_b32 v6, 5, v4
    v_lshlrev_b32 v7, 4, v5
    v_sub_u32 v10, v7, v6
    v_add_u32 v10, 480, v10
    v_add_u32 v10, s57, v10
    v_lshl_add_u32 v11, v5, 3, v6
    v_add_u32 v11, s57, v11
    v_and_b32 v8, 3, v0
    v_mul_u32_u24 v12, 12928, v8
    v_lshrrev_b32 v8, 2, v0
    v_lshl_add_u32 v12, v8, 4, v12
    s_lshl_b32 s56, s28, 10
    v_add_u32 v12, s56, v12
    v_lshrrev_b32 v6, 1, v4
    v_lshlrev_b32 v6, 2, v6
    v_add_u32 v6, v6, v7
    v_and_b32 v8, 1, v4
    v_mul_u32_u24 v8, 4160, v8
    v_sub_u32 v6, v6, v8
    v_add_u32 v6, 8772, v6
    v_add_u32 v16, s57, v6
    v_add_u32 v17, 1024, v16
    v_add_u32 v18, 2048, v16
    v_add_u32 v19, 3072, v16
    s_mov_b32 exec_hi, 0
    ds_write_b128 v2, v[24:27] offset:4096
    s_mov_b32 exec_lo, 3
    ds_write_b128 v2, v[24:27] offset:4608
    ds_write_b128 v2, v[24:27] offset:8768
    s_mov_b64 exec, -1
    v_lshlrev_b32 v6, 3, v5
    v_add_u32 v6, v6, v4
    v_sub_u32 v6, 15, v6
    v_and_b32 v7, 1, v6
    v_lshlrev_b32 v7, 4, v7
    v_ashrrev_i32 v6, 1, v6
    v_and_b32 v3, -64, v13
    v_add_u32 v3, s56, v3
    v_add_u32 v3, 38784, v3
    v_lshlrev_b32 v8, 2, v0
    s_mov_b64 exec, 15
    s_mov_b32 s30, 1048576
Llw_52:
    ds_read_b32 v9, v8 offset:62016
    s_waitcnt lgkmcnt(0)
    v_cmp_eq_u32 vcc, 0, v9
    s_sub_u32 s30, s30, 1
    s_cbranch_scc1 Llwd_53
    s_cbranch_vccz Llwd_53
    s_sleep 1
    s_branch Llw_52
Llwd_53:
    s_mov_b64 exec, -1
    s_mov_b32 s75, 131072
    s_mov_b32 s44, 0x88888888
    s_mov_b32 s45, 0x88888888
    buffer_load_dwordx4 v[156:159], v13, s[36:39], s67 offen offset:0 sc1
    buffer_load_dwordx4 v[160:163], v13, s[36:39], s67 offen offset:1024 sc1
    buffer_load_dwordx4 v[164:167], v13, s[36:39], s67 offen offset:2048 sc1
    buffer_load_dwordx4 v[168:171], v13, s[36:39], s67 offen offset:3072 sc1
    buffer_load_dwordx4 v[172:175], v13, s[36:39], s66 offen sc1
    s_cmp_lg_u32 s28, 3
    s_cbranch_scc1 Lnh_57
    s_waitcnt vmcnt(18)
    v_mov_b32 v8, 62304
    v_mov_b32 v9, 1
    s_mov_b64 exec, 1
    ds_write_b32 v8, v9
    s_mov_b64 exec, -1
    s_waitcnt vmcnt(14)
    v_mov_b32 v8, 62308
    v_mov_b32 v9, 1
    s_mov_b64 exec, 1
    ds_write_b32 v8, v9
    s_mov_b64 exec, -1
    s_waitcnt vmcnt(10)
    v_mov_b32 v8, 62312
    v_mov_b32 v9, 1
    s_mov_b64 exec, 1
    ds_write_b32 v8, v9
    s_mov_b64 exec, -1
    s_waitcnt vmcnt(6)
    v_mov_b32 v8, 62316
    v_mov_b32 v9, 1
    s_mov_b64 exec, 1
    ds_write_b32 v8, v9
    s_mov_b64 exec, -1
Lnh_57:
    s_mov_b32 s75, 131072
    s_mov_b64 s[90:91], -1
    s_mov_b64 s[92:93], -1
    s_mov_b64 s[94:95], -1
    s_mov_b64 s[96:97], -1
    s_mov_b64 s[98:99], -1
    s_branch Llti_56
Llt_54:
    s_mov_b64 exec, s[90:91]
    s_cbranch_execz Lls_58
    buffer_load_dwordx4 v[156:159], v13, s[36:39], s67 offen offset:0 sc1
Lls_58:
    s_mov_b64 exec, s[92:93]
    s_cbranch_execz Lls_59
    buffer_load_dwordx4 v[160:163], v13, s[36:39], s67 offen offset:1024 sc1
Lls_59:
    s_mov_b64 exec, s[94:95]
    s_cbranch_execz Lls_60
    buffer_load_dwordx4 v[164:167], v13, s[36:39], s67 offen offset:2048 sc1
Lls_60:
    s_mov_b64 exec, s[96:97]
    s_cbranch_execz Lls_61
    buffer_load_dwordx4 v[168:171], v13, s[36:39], s67 offen offset:3072 sc1
Lls_61:
    s_mov_b64 exec, s[98:99]
    s_cbranch_execz Lls_62
    buffer_load_dwordx4 v[172:175], v13, s[36:39], s66 offen sc1
Lls_62:
Llti_56:
    s_mov_b64 exec, s[44:45]
    s_mov_b64 s[46:47], 0
    s_waitcnt vmcnt(0)
    v_cmp_ne_u32 vcc, s29, v159
    s_nop 1
    s_and_b64 s[90:91], s[90:91], vcc
    s_lshr_b64 vcc, s[90:91], 1
    s_or_b64 s[90:91], s[90:91], vcc
    s_lshr_b64 vcc, s[90:91], 2
    s_or_b64 s[90:91], s[90:91], vcc
    s_or_b64 s[46:47], s[46:47], s[90:91]
    v_cmp_ne_u32 vcc, s29, v163
    s_nop 1
    s_and_b64 s[92:93], s[92:93], vcc
    s_lshr_b64 vcc, s[92:93], 1
    s_or_b64 s[92:93], s[92:93], vcc
    s_lshr_b64 vcc, s[92:93], 2
    s_or_b64 s[92:93], s[92:93], vcc
    s_or_b64 s[46:47], s[46:47], s[92:93]
    v_cmp_ne_u32 vcc, s29, v167
    s_nop 1
    s_and_b64 s[94:95], s[94:95], vcc
    s_lshr_b64 vcc, s[94:95], 1
    s_or_b64 s[94:95], s[94:95], vcc
    s_lshr_b64 vcc, s[94:95], 2
    s_or_b64 s[94:95], s[94:95], vcc
    s_or_b64 s[46:47], s[46:47], s[94:95]
    v_cmp_ne_u32 vcc, s29, v171
    s_nop 1
    s_and_b64 s[96:97], s[96:97], vcc
    s_lshr_b64 vcc, s[96:97], 1
    s_or_b64 s[96:97], s[96:97], vcc
    s_lshr_b64 vcc, s[96:97], 2
    s_or_b64 s[96:97], s[96:97], vcc
    s_or_b64 s[46:47], s[46:47], s[96:97]
    v_cmp_ne_u32 vcc, s29, v175
    s_nop 1
    s_and_b64 s[98:99], s[98:99], vcc
    s_lshr_b64 vcc, s[98:99], 1
    s_or_b64 s[98:99], s[98:99], vcc
    s_lshr_b64 vcc, s[98:99], 2
    s_or_b64 s[98:99], s[98:99], vcc
    s_or_b64 s[46:47], s[46:47], s[98:99]
    s_cbranch_scc0 Lltd_55
    s_sub_u32 s75, s75, 1
    s_cbranch_scc1 Lltd_55
    s_sleep 2
    s_branch Llt_54
Lltd_55:
    s_mov_b64 exec, -1
    s_mov_b32 exec_lo, 0x77777777
    s_mov_b32 exec_hi, 0x77777777
    ds_write_b128 v12, v[156:159] offset:0
    ds_write_b128 v12, v[160:163] offset:256
    ds_write_b128 v12, v[164:167] offset:512
    ds_write_b128 v12, v[168:171] offset:768
    s_mov_b64 exec, s[44:45]
    ds_write_b64 v12, v[156:157] offset:0
    ds_write_b32 v12, v158 offset:8
    ds_write_b64 v12, v[160:161] offset:256
    ds_write_b32 v12, v162 offset:264
    ds_write_b64 v12, v[164:165] offset:512
    ds_write_b32 v12, v166 offset:520
    ds_write_b64 v12, v[168:169] offset:768
    ds_write_b32 v12, v170 offset:776
    s_mov_b32 exec_lo, 0x11111111
    s_mov_b32 exec_hi, 0x11111111
    ds_write2_b32 v3, v172, v173 offset0:3 offset1:7
    ds_write2_b32 v3, v174, v175 offset0:11 offset1:15
    s_mov_b64 exec, -1
    s_add_u32 s44, s26, 9961472
    s_addc_u32 s45, s27, 0
    s_mov_b32 s46, 2949120
    s_mov_b32 s47, 0x20000
    s_lshl_b32 s30, s28, 2
    s_add_u32 s30, s30, 62112
    v_mov_b32 v28, s30
    v_mov_b32 v29, 1
    s_mov_b64 exec, 1
    ds_write_b32 v28, v29
    s_mov_b64 exec, -1
    s_lshl_b32 s70, s28, 2
    v_lshl_add_u32 v8, v0, 2, s70
    s_mov_b64 exec, 1
    s_mov_b32 s30, 1048576
Llw_63:
    ds_read_b32 v9, v8 offset:62304
    s_waitcnt lgkmcnt(0)
    v_cmp_eq_u32 vcc, 0, v9
    s_sub_u32 s30, s30, 1
    s_cbranch_scc1 Llwd_64
    s_cbranch_vccz Llwd_64
    s_sleep 1
    s_branch Llw_63
Llwd_64:
    s_mov_b64 exec, -1
    ds_read_b128 v[60:63], v2 offset:4640
    ds_read_b128 v[64:67], v2 offset:5664
    ds_read_b128 v[68:71], v2 offset:6688
    ds_read_b128 v[72:75], v2 offset:7712
    ds_read_b32 v92, v2 offset:4636
    ds_read_b32 v93, v2 offset:5660
    ds_read_b32 v94, v2 offset:6684
    ds_read_b32 v95, v2 offset:7708
    s_waitcnt lgkmcnt(7)
    v_alignbit_b32 v97, v61, v60, 16
    v_alignbit_b32 v98, v62, v61, 16
    v_alignbit_b32 v99, v63, v62, 16
    s_waitcnt lgkmcnt(3)
    v_alignbit_b32 v96, v60, v92, 16
    ds_write_b128 v2, v[96:99] offset:8800
    v_alignbit_b32 v101, v65, v64, 16
    v_alignbit_b32 v102, v66, v65, 16
    v_alignbit_b32 v103, v67, v66, 16
    s_waitcnt lgkmcnt(3)
    v_alignbit_b32 v100, v64, v93, 16
    ds_write_b128 v2, v[100:103] offset:9824
    v_alignbit_b32 v105, v69, v68, 16
    v_alignbit_b32 v106, v70, v69, 16
    v_alignbit_b32 v107, v71, v70, 16
    s_waitcnt lgkmcnt(3)
    v_alignbit_b32 v104, v68, v94, 16
    ds_write_b128 v2, v[104:107] offset:10848
    v_alignbit_b32 v109, v73, v72, 16
    v_alignbit_b32 v110, v74, v73, 16
    v_alignbit_b32 v111, v75, v74, 16
    s_waitcnt lgkmcnt(3)
    v_alignbit_b32 v108, v72, v95, 16
    ds_write_b128 v2, v[108:111] offset:11872
    s_waitcnt vmcnt(5)
    v_lshlrev_b32 v14, v7, v14
    v_cmp_eq_u32 vcc, 0, v6
    s_nop 1
    v_cndmask_b32 v20, 0, v14, vcc
    v_cmp_eq_u32 vcc, 1, v6
    s_nop 1
    v_cndmask_b32 v21, 0, v14, vcc
    v_cmp_eq_u32 vcc, 2, v6
    s_nop 1
    v_cndmask_b32 v22, 0, v14, vcc
    v_cmp_eq_u32 vcc, 3, v6
    s_nop 1
    v_cndmask_b32 v23, 0, v14, vcc
    ds_read2_b32 v[60:61], v16 offset0:0 offset1:1
    ds_read2_b32 v[62:63], v16 offset0:2 offset1:3
    ds_read2_b32 v[64:65], v16 offset0:128 offset1:129
    ds_read2_b32 v[66:67], v16 offset0:130 offset1:131
    ds_read2_b32 v[68:69], v17 offset0:0 offset1:1
    ds_read2_b32 v[70:71], v17 offset0:2 offset1:3
    ds_read2_b32 v[72:73], v17 offset0:128 offset1:129
    ds_read2_b32 v[74:75], v17 offset0:130 offset1:131
    ds_read2_b32 v[76:77], v18 offset0:0 offset1:1
    ds_read2_b32 v[78:79], v18 offset0:2 offset1:3
    ds_read2_b32 v[80:81], v18 offset0:128 offset1:129
    ds_read2_b32 v[82:83], v18 offset0:130 offset1:131
    ds_read2_b32 v[84:85], v19 offset0:0 offset1:1
    ds_read2_b32 v[86:87], v19 offset0:2 offset1:3
    ds_read2_b32 v[88:89], v19 offset0:128 offset1:129
    ds_read2_b32 v[90:91], v19 offset0:130 offset1:131
    ds_read2_b32 v[92:93], v16 offset0:16 offset1:17
    ds_read2_b32 v[94:95], v16 offset0:18 offset1:19
    ds_read2_b32 v[96:97], v16 offset0:144 offset1:145
    ds_read2_b32 v[98:99], v16 offset0:146 offset1:147
    ds_read2_b32 v[100:101], v17 offset0:16 offset1:17
    ds_read2_b32 v[102:103], v17 offset0:18 offset1:19
    ds_read2_b32 v[104:105], v17 offset0:144 offset1:145
    ds_read2_b32 v[106:107], v17 offset0:146 offset1:147
    ds_read2_b32 v[108:109], v18 offset0:16 offset1:17
    ds_read2_b32 v[110:111], v18 offset0:18 offset1:19
    ds_read2_b32 v[112:113], v18 offset0:144 offset1:145
    ds_read2_b32 v[114:115], v18 offset0:146 offset1:147
    ds_read2_b32 v[116:117], v19 offset0:16 offset1:17
    ds_read2_b32 v[118:119], v19 offset0:18 offset1:19
    ds_read2_b32 v[120:121], v19 offset0:144 offset1:145
    ds_read2_b32 v[122:123], v19 offset0:146 offset1:147
    v_lshlrev_b32 v28, 2, v0
    s_mov_b64 exec, 15
    s_mov_b32 s30, 1048576
Llw_65:
    ds_read_b32 v29, v28 offset:62112
    s_waitcnt lgkmcnt(0)
    v_cmp_eq_u32 vcc, 0, v29
    s_sub_u32 s30, s30, 1
    s_cbranch_scc1 Llwd_66
    s_cbranch_vccnz Llw_65
Llwd_66:
    s_mov_b64 exec, -1
    ds_read_b128 v[124:127], v10 offset:3584
    ds_read_b128 v[128:131], v10 offset:3072
    ds_read_b128 v[132:135], v10 offset:2560
    ds_read_b128 v[136:139], v10 offset:2048
    ds_read_b128 v[140:143], v10 offset:1536
    ds_read_b128 v[144:147], v10 offset:1024
    ds_read_b128 v[148:151], v10 offset:512
    ds_read_b128 v[152:155], v10 offset:0
    s_mov_b32 s40, s10
    s_mov_b32 s41, s11
    s_mov_b32 s42, 2621440
    s_mov_b32 s43, 0x20000
    s_mov_b32 s69, 5120
    s_waitcnt lgkmcnt(7)
    v_mfma_f32_16x16x32_bf16 v[28:31], v[20:23], v[124:127], 0
    v_mfma_f32_16x16x32_bf16 v[28:31], v[60:63], v[124:127], v[28:31]
    v_mfma_f32_16x16x32_bf16 v[32:35], v[64:67], v[124:127], 0
    v_mfma_f32_16x16x32_bf16 v[36:39], v[68:71], v[124:127], 0
    v_mfma_f32_16x16x32_bf16 v[40:43], v[72:75], v[124:127], 0
    v_mfma_f32_16x16x32_bf16 v[44:47], v[76:79], v[124:127], 0
    v_mfma_f32_16x16x32_bf16 v[48:51], v[80:83], v[124:127], 0
    v_mfma_f32_16x16x32_bf16 v[52:55], v[84:87], v[124:127], 0
    v_mfma_f32_16x16x32_bf16 v[56:59], v[88:91], v[124:127], 0
    s_waitcnt lgkmcnt(6)
    v_mfma_f32_16x16x32_bf16 v[32:35], v[20:23], v[128:131], v[32:35]
    v_mfma_f32_16x16x32_bf16 v[32:35], v[60:63], v[128:131], v[32:35]
    v_mfma_f32_16x16x32_bf16 v[36:39], v[64:67], v[128:131], v[36:39]
    v_mfma_f32_16x16x32_bf16 v[40:43], v[68:71], v[128:131], v[40:43]
    v_mfma_f32_16x16x32_bf16 v[44:47], v[72:75], v[128:131], v[44:47]
    v_mfma_f32_16x16x32_bf16 v[48:51], v[76:79], v[128:131], v[48:51]
    v_mfma_f32_16x16x32_bf16 v[52:55], v[80:83], v[128:131], v[52:55]
    v_mfma_f32_16x16x32_bf16 v[56:59], v[84:87], v[128:131], v[56:59]
    ds_read_b128 v[156:159], v10 offset:3648
    s_waitcnt lgkmcnt(6)
    v_mfma_f32_16x16x32_bf16 v[36:39], v[20:23], v[132:135], v[36:39]
    v_mfma_f32_16x16x32_bf16 v[36:39], v[60:63], v[132:135], v[36:39]
    v_mfma_f32_16x16x32_bf16 v[40:43], v[64:67], v[132:135], v[40:43]
    ds_read_b128 v[160:163], v10 offset:3136
    v_mfma_f32_16x16x32_bf16 v[44:47], v[68:71], v[132:135], v[44:47]
    v_mfma_f32_16x16x32_bf16 v[48:51], v[72:75], v[132:135], v[48:51]
    ds_read_b128 v[164:167], v10 offset:2624
    v_mfma_f32_16x16x32_bf16 v[52:55], v[76:79], v[132:135], v[52:55]
    v_mfma_f32_16x16x32_bf16 v[56:59], v[80:83], v[132:135], v[56:59]
    ds_read_b128 v[168:171], v10 offset:2112
    s_waitcnt lgkmcnt(8)
    v_mfma_f32_16x16x32_bf16 v[40:43], v[20:23], v[136:139], v[40:43]
    v_mfma_f32_16x16x32_bf16 v[40:43], v[60:63], v[136:139], v[40:43]
    v_mfma_f32_16x16x32_bf16 v[44:47], v[64:67], v[136:139], v[44:47]
    v_mfma_f32_16x16x32_bf16 v[48:51], v[68:71], v[136:139], v[48:51]
    ds_read_b128 v[172:175], v10 offset:1600
    v_mfma_f32_16x16x32_bf16 v[52:55], v[72:75], v[136:139], v[52:55]
    v_mfma_f32_16x16x32_bf16 v[56:59], v[76:79], v[136:139], v[56:59]
    ds_read_b128 v[176:179], v10 offset:1088
    s_waitcnt lgkmcnt(9)
    v_mfma_f32_16x16x32_bf16 v[44:47], v[20:23], v[140:143], v[44:47]
    v_mfma_f32_16x16x32_bf16 v[44:47], v[60:63], v[140:143], v[44:47]
    v_mfma_f32_16x16x32_bf16 v[48:51], v[64:67], v[140:143], v[48:51]
    ds_read_b128 v[180:183], v10 offset:576
    v_mfma_f32_16x16x32_bf16 v[52:55], v[68:71], v[140:143], v[52:55]
    v_mfma_f32_16x16x32_bf16 v[56:59], v[72:75], v[140:143], v[56:59]
    ds_read_b128 v[184:187], v10 offset:64
    s_waitcnt lgkmcnt(10)
    v_mfma_f32_16x16x32_bf16 v[48:51], v[20:23], v[144:147], v[48:51]
    v_mfma_f32_16x16x32_bf16 v[48:51], v[60:63], v[144:147], v[48:51]
    v_mfma_f32_16x16x32_bf16 v[52:55], v[64:67], v[144:147], v[52:55]
    v_mfma_f32_16x16x32_bf16 v[56:59], v[68:71], v[144:147], v[56:59]
    s_waitcnt lgkmcnt(9)
    v_mfma_f32_16x16x32_bf16 v[52:55], v[20:23], v[148:151], v[52:55]
    v_mfma_f32_16x16x32_bf16 v[52:55], v[60:63], v[148:151], v[52:55]
    v_mfma_f32_16x16x32_bf16 v[56:59], v[64:67], v[148:151], v[56:59]
    s_waitcnt lgkmcnt(8)
    v_mfma_f32_16x16x32_bf16 v[56:59], v[20:23], v[152:155], v[56:59]
    v_mfma_f32_16x16x32_bf16 v[56:59], v[60:63], v[152:155], v[56:59]
    s_waitcnt lgkmcnt(7)
    v_mfma_f32_16x16x32_bf16 v[28:31], v[92:95], v[156:159], v[28:31]
    s_waitcnt lgkmcnt(6)
    v_mfma_f32_16x16x32_bf16 v[32:35], v[92:95], v[160:163], v[32:35]
    ds_read_b128 v[124:127], v10 offset:3712
    buffer_load_dwordx2 v[240:241], v239, s[40:43], 0 offen offset:0 nt
    v_mfma_f32_16x16x32_bf16 v[32:35], v[96:99], v[156:159], v[32:35]
    ds_read2_b32 v[60:61], v16 offset0:32 offset1:33
    v_mfma_f32_16x16x32_bf16 v[36:39], v[96:99], v[160:163], v[36:39]
    ds_read2_b32 v[62:63], v16 offset0:34 offset1:35
    s_waitcnt lgkmcnt(8)
    v_mfma_f32_16x16x32_bf16 v[36:39], v[92:95], v[164:167], v[36:39]
    ds_read_b128 v[128:131], v10 offset:3200
    v_mfma_f32_16x16x32_bf16 v[36:39], v[100:103], v[156:159], v[36:39]
    buffer_load_dwordx2 v[242:243], v239, s[40:43], 0 offen offset:1280 nt
    v_mfma_f32_16x16x32_bf16 v[40:43], v[96:99], v[164:167], v[40:43]
    ds_read2_b32 v[64:65], v16 offset0:160 offset1:161
    v_mfma_f32_16x16x32_bf16 v[40:43], v[100:103], v[160:163], v[40:43]
    ds_read2_b32 v[66:67], v16 offset0:162 offset1:163
    v_mfma_f32_16x16x32_bf16 v[44:47], v[100:103], v[164:167], v[44:47]
    ds_read_b128 v[132:135], v10 offset:2688
    s_waitcnt lgkmcnt(11)
    v_mfma_f32_16x16x32_bf16 v[40:43], v[92:95], v[168:171], v[40:43]
    ds_read2_b32 v[68:69], v17 offset0:32 offset1:33
    buffer_load_dwordx2 v[244:245], v239, s[40:43], 0 offen offset:2560 nt
    v_mfma_f32_16x16x32_bf16 v[40:43], v[104:107], v[156:159], v[40:43]
    v_mfma_f32_16x16x32_bf16 v[44:47], v[96:99], v[168:171], v[44:47]
    ds_read2_b32 v[70:71], v17 offset0:34 offset1:35
    v_mfma_f32_16x16x32_bf16 v[44:47], v[104:107], v[160:163], v[44:47]
    ds_read_b128 v[136:139], v10 offset:2176
    v_mfma_f32_16x16x32_bf16 v[48:51], v[100:103], v[168:171], v[48:51]
    ds_read2_b32 v[72:73], v17 offset0:160 offset1:161
    buffer_load_dwordx2 v[246:247], v239, s[40:43], 0 offen offset:3840 nt
    v_mfma_f32_16x16x32_bf16 v[48:51], v[104:107], v[164:167], v[48:51]
    ds_read2_b32 v[74:75], v17 offset0:162 offset1:163
    v_mfma_f32_16x16x32_bf16 v[52:55], v[104:107], v[168:171], v[52:55]
    s_waitcnt lgkmcnt(15)
    v_mfma_f32_16x16x32_bf16 v[44:47], v[92:95], v[172:175], v[44:47]
    ds_read_b128 v[140:143], v10 offset:1664
    v_mfma_f32_16x16x32_bf16 v[44:47], v[108:111], v[156:159], v[44:47]
    ds_read2_b32 v[76:77], v18 offset0:32 offset1:33
    buffer_load_dwordx2 v[248:249], v239, s[40:43], s69 offen offset:0 nt
    v_mfma_f32_16x16x32_bf16 v[48:51], v[96:99], v[172:175], v[48:51]
    ds_read2_b32 v[78:79], v18 offset0:34 offset1:35
    v_mfma_f32_16x16x32_bf16 v[48:51], v[108:111], v[160:163], v[48:51]
    ds_read_b128 v[144:147], v10 offset:1152
    v_mfma_f32_16x16x32_bf16 v[52:55], v[100:103], v[172:175], v[52:55]
    v_mfma_f32_16x16x32_bf16 v[52:55], v[108:111], v[164:167], v[52:55]
    ds_read2_b32 v[80:81], v18 offset0:160 offset1:161
    buffer_load_dwordx2 v[250:251], v239, s[40:43], s69 offen offset:1280 nt
    v_mfma_f32_16x16x32_bf16 v[56:59], v[104:107], v[172:175], v[56:59]
    ds_read2_b32 v[82:83], v18 offset0:162 offset1:163
    v_mfma_f32_16x16x32_bf16 v[56:59], v[108:111], v[168:171], v[56:59]
    ds_read_b128 v[148:151], v10 offset:640
    s_waitcnt lgkmcnt(15)
    v_mfma_f32_16x16x32_bf16 v[48:51], v[92:95], v[176:179], v[48:51]
    ds_read2_b32 v[84:85], v19 offset0:32 offset1:33
    v_mfma_f32_16x16x32_bf16 v[48:51], v[112:115], v[156:159], v[48:51]
    buffer_load_dwordx2 v[252:253], v239, s[40:43], s69 offen offset:2560 nt
    v_mfma_f32_16x16x32_bf16 v[52:55], v[96:99], v[176:179], v[52:55]
    ds_read2_b32 v[86:87], v19 offset0:34 offset1:35
    v_mfma_f32_16x16x32_bf16 v[52:55], v[112:115], v[160:163], v[52:55]
    ds_read_b128 v[152:155], v10 offset:128
    v_mfma_f32_16x16x32_bf16 v[56:59], v[100:103], v[176:179], v[56:59]
    ds_read2_b32 v[88:89], v19 offset0:160 offset1:161
    v_mfma_f32_16x16x32_bf16 v[56:59], v[112:115], v[164:167], v[56:59]
    ds_read2_b32 v[90:91], v19 offset0:162 offset1:163
    buffer_load_dwordx2 v[254:255], v239, s[40:43], s69 offen offset:3840 nt
    v_mfma_f32_16x16x32_bf16 v[52:55], v[92:95], v[180:183], v[52:55]
    v_mfma_f32_16x16x32_bf16 v[52:55], v[116:119], v[156:159], v[52:55]
    v_mfma_f32_16x16x32_bf16 v[56:59], v[96:99], v[180:183], v[56:59]
    v_mfma_f32_16x16x32_bf16 v[56:59], v[116:119], v[160:163], v[56:59]
    v_mfma_f32_16x16x32_bf16 v[56:59], v[92:95], v[184:187], v[56:59]
    v_mfma_f32_16x16x32_bf16 v[56:59], v[120:123], v[156:159], v[56:59]
    v_mfma_f32_16x16x32_bf16 v[28:31], v[60:63], v[124:127], v[28:31]
    v_mfma_f32_16x16x32_bf16 v[32:35], v[60:63], v[128:131], v[32:35]
    ds_read_b128 v[156:159], v10 offset:3776
    s_waitcnt lgkmcnt(15)
    v_mfma_f32_16x16x32_bf16 v[32:35], v[64:67], v[124:127], v[32:35]
    ds_read2_b32 v[92:93], v16 offset0:48 offset1:49
    v_mfma_f32_16x16x32_bf16 v[36:39], v[64:67], v[128:131], v[36:39]
    ds_read2_b32 v[94:95], v16 offset0:50 offset1:51
    v_mfma_f32_16x16x32_bf16 v[36:39], v[60:63], v[132:135], v[36:39]
    ds_read_b128 v[160:163], v10 offset:3264
    v_mfma_f32_16x16x32_bf16 v[36:39], v[68:71], v[124:127], v[36:39]
    v_mfma_f32_16x16x32_bf16 v[40:43], v[64:67], v[132:135], v[40:43]
    ds_read2_b32 v[96:97], v16 offset0:176 offset1:177
    v_mfma_f32_16x16x32_bf16 v[40:43], v[68:71], v[128:131], v[40:43]
    ds_read2_b32 v[98:99], v16 offset0:178 offset1:179
    v_mfma_f32_16x16x32_bf16 v[44:47], v[68:71], v[132:135], v[44:47]
    ds_read_b128 v[164:167], v10 offset:2752
    v_mfma_f32_16x16x32_bf16 v[40:43], v[60:63], v[136:139], v[40:43]
    ds_read2_b32 v[100:101], v17 offset0:48 offset1:49
    s_waitcnt lgkmcnt(15)
    v_mfma_f32_16x16x32_bf16 v[40:43], v[72:75], v[124:127], v[40:43]
    v_mfma_f32_16x16x32_bf16 v[44:47], v[64:67], v[136:139], v[44:47]
    ds_read2_b32 v[102:103], v17 offset0:50 offset1:51
    v_mfma_f32_16x16x32_bf16 v[44:47], v[72:75], v[128:131], v[44:47]
    ds_read_b128 v[168:171], v10 offset:2240
    v_mfma_f32_16x16x32_bf16 v[48:51], v[68:71], v[136:139], v[48:51]
    ds_read2_b32 v[104:105], v17 offset0:176 offset1:177
    v_mfma_f32_16x16x32_bf16 v[48:51], v[72:75], v[132:135], v[48:51]
    ds_read2_b32 v[106:107], v17 offset0:178 offset1:179
    v_mfma_f32_16x16x32_bf16 v[52:55], v[72:75], v[136:139], v[52:55]
    v_mfma_f32_16x16x32_bf16 v[44:47], v[60:63], v[140:143], v[44:47]
    ds_read_b128 v[172:175], v10 offset:1728
    v_mfma_f32_16x16x32_bf16 v[44:47], v[76:79], v[124:127], v[44:47]
    ds_read2_b32 v[108:109], v18 offset0:48 offset1:49
    v_mfma_f32_16x16x32_bf16 v[48:51], v[64:67], v[140:143], v[48:51]
    ds_read2_b32 v[110:111], v18 offset0:50 offset1:51
    v_mfma_f32_16x16x32_bf16 v[48:51], v[76:79], v[128:131], v[48:51]
    ds_read_b128 v[176:179], v10 offset:1216
    v_mfma_f32_16x16x32_bf16 v[52:55], v[68:71], v[140:143], v[52:55]
    v_mfma_f32_16x16x32_bf16 v[52:55], v[76:79], v[132:135], v[52:55]
    ds_read2_b32 v[112:113], v18 offset0:176 offset1:177
    v_mfma_f32_16x16x32_bf16 v[56:59], v[72:75], v[140:143], v[56:59]
    ds_read2_b32 v[114:115], v18 offset0:178 offset1:179
    v_mfma_f32_16x16x32_bf16 v[56:59], v[76:79], v[136:139], v[56:59]
    ds_read_b128 v[180:183], v10 offset:704
    v_mfma_f32_16x16x32_bf16 v[48:51], v[60:63], v[144:147], v[48:51]
    ds_read2_b32 v[116:117], v19 offset0:48 offset1:49
    s_waitcnt lgkmcnt(15)
    v_mfma_f32_16x16x32_bf16 v[48:51], v[80:83], v[124:127], v[48:51]
    v_mfma_f32_16x16x32_bf16 v[52:55], v[64:67], v[144:147], v[52:55]
    ds_read2_b32 v[118:119], v19 offset0:50 offset1:51
    v_mfma_f32_16x16x32_bf16 v[52:55], v[80:83], v[128:131], v[52:55]
    ds_read_b128 v[184:187], v10 offset:192
    v_mfma_f32_16x16x32_bf16 v[56:59], v[68:71], v[144:147], v[56:59]
    ds_read2_b32 v[120:121], v19 offset0:176 offset1:177
    v_mfma_f32_16x16x32_bf16 v[56:59], v[80:83], v[132:135], v[56:59]
    ds_read2_b32 v[122:123], v19 offset0:178 offset1:179
    v_mfma_f32_16x16x32_bf16 v[52:55], v[60:63], v[148:151], v[52:55]
    v_mfma_f32_16x16x32_bf16 v[52:55], v[84:87], v[124:127], v[52:55]
    v_mfma_f32_16x16x32_bf16 v[56:59], v[64:67], v[148:151], v[56:59]
    v_mfma_f32_16x16x32_bf16 v[56:59], v[84:87], v[128:131], v[56:59]
    v_mfma_f32_16x16x32_bf16 v[56:59], v[60:63], v[152:155], v[56:59]
    v_mfma_f32_16x16x32_bf16 v[56:59], v[88:91], v[124:127], v[56:59]
    v_mfma_f32_16x16x32_bf16 v[28:31], v[92:95], v[156:159], v[28:31]
    v_mfma_f32_16x16x32_bf16 v[32:35], v[92:95], v[160:163], v[32:35]
    ds_read_b128 v[124:127], v10 offset:3840
    s_waitcnt lgkmcnt(15)
    v_mfma_f32_16x16x32_bf16 v[32:35], v[96:99], v[156:159], v[32:35]
    ds_read2_b32 v[60:61], v16 offset0:64 offset1:65
    v_mfma_f32_16x16x32_bf16 v[36:39], v[96:99], v[160:163], v[36:39]
    ds_read2_b32 v[62:63], v16 offset0:66 offset1:67
    v_mfma_f32_16x16x32_bf16 v[36:39], v[92:95], v[164:167], v[36:39]
    ds_read_b128 v[128:131], v10 offset:3328
    v_mfma_f32_16x16x32_bf16 v[36:39], v[100:103], v[156:159], v[36:39]
    v_mfma_f32_16x16x32_bf16 v[40:43], v[96:99], v[164:167], v[40:43]
    ds_read2_b32 v[64:65], v16 offset0:192 offset1:193
    v_mfma_f32_16x16x32_bf16 v[40:43], v[100:103], v[160:163], v[40:43]
    ds_read2_b32 v[66:67], v16 offset0:194 offset1:195
    v_mfma_f32_16x16x32_bf16 v[44:47], v[100:103], v[164:167], v[44:47]
    ds_read_b128 v[132:135], v10 offset:2816
    v_mfma_f32_16x16x32_bf16 v[40:43], v[92:95], v[168:171], v[40:43]
    ds_read2_b32 v[68:69], v17 offset0:64 offset1:65
    s_waitcnt lgkmcnt(15)
    v_mfma_f32_16x16x32_bf16 v[40:43], v[104:107], v[156:159], v[40:43]
    v_mfma_f32_16x16x32_bf16 v[44:47], v[96:99], v[168:171], v[44:47]
    ds_read2_b32 v[70:71], v17 offset0:66 offset1:67
    v_mfma_f32_16x16x32_bf16 v[44:47], v[104:107], v[160:163], v[44:47]
    ds_read_b128 v[136:139], v10 offset:2304
    v_mfma_f32_16x16x32_bf16 v[48:51], v[100:103], v[168:171], v[48:51]
    ds_read2_b32 v[72:73], v17 offset0:192 offset1:193
    v_mfma_f32_16x16x32_bf16 v[48:51], v[104:107], v[164:167], v[48:51]
    ds_read2_b32 v[74:75], v17 offset0:194 offset1:195
    v_mfma_f32_16x16x32_bf16 v[52:55], v[104:107], v[168:171], v[52:55]
    v_mfma_f32_16x16x32_bf16 v[44:47], v[92:95], v[172:175], v[44:47]
    ds_read_b128 v[140:143], v10 offset:1792
    v_mfma_f32_16x16x32_bf16 v[44:47], v[108:111], v[156:159], v[44:47]
    ds_read2_b32 v[76:77], v18 offset0:64 offset1:65
    v_mfma_f32_16x16x32_bf16 v[48:51], v[96:99], v[172:175], v[48:51]
    ds_read2_b32 v[78:79], v18 offset0:66 offset1:67
    v_mfma_f32_16x16x32_bf16 v[48:51], v[108:111], v[160:163], v[48:51]
    ds_read_b128 v[144:147], v10 offset:1280
    v_mfma_f32_16x16x32_bf16 v[52:55], v[100:103], v[172:175], v[52:55]
    v_mfma_f32_16x16x32_bf16 v[52:55], v[108:111], v[164:167], v[52:55]
    ds_read2_b32 v[80:81], v18 offset0:192 offset1:193
    v_mfma_f32_16x16x32_bf16 v[56:59], v[104:107], v[172:175], v[56:59]
    ds_read2_b32 v[82:83], v18 offset0:194 offset1:195
    v_mfma_f32_16x16x32_bf16 v[56:59], v[108:111], v[168:171], v[56:59]
    ds_read_b128 v[148:151], v10 offset:768
    v_mfma_f32_16x16x32_bf16 v[48:51], v[92:95], v[176:179], v[48:51]
    ds_read2_b32 v[84:85], v19 offset0:64 offset1:65
    s_waitcnt lgkmcnt(15)
    v_mfma_f32_16x16x32_bf16 v[48:51], v[112:115], v[156:159], v[48:51]
    v_mfma_f32_16x16x32_bf16 v[52:55], v[96:99], v[176:179], v[52:55]
    ds_read2_b32 v[86:87], v19 offset0:66 offset1:67
    v_mfma_f32_16x16x32_bf16 v[52:55], v[112:115], v[160:163], v[52:55]
    ds_read_b128 v[152:155], v10 offset:256
    v_mfma_f32_16x16x32_bf16 v[56:59], v[100:103], v[176:179], v[56:59]
    ds_read2_b32 v[88:89], v19 offset0:192 offset1:193
    v_mfma_f32_16x16x32_bf16 v[56:59], v[112:115], v[164:167], v[56:59]
    ds_read2_b32 v[90:91], v19 offset0:194 offset1:195
    v_mfma_f32_16x16x32_bf16 v[52:55], v[92:95], v[180:183], v[52:55]
    v_mfma_f32_16x16x32_bf16 v[52:55], v[116:119], v[156:159], v[52:55]
    v_mfma_f32_16x16x32_bf16 v[56:59], v[96:99], v[180:183], v[56:59]
    v_mfma_f32_16x16x32_bf16 v[56:59], v[116:119], v[160:163], v[56:59]
    v_mfma_f32_16x16x32_bf16 v[56:59], v[92:95], v[184:187], v[56:59]
    v_mfma_f32_16x16x32_bf16 v[56:59], v[120:123], v[156:159], v[56:59]
    v_mfma_f32_16x16x32_bf16 v[28:31], v[60:63], v[124:127], v[28:31]
    v_mfma_f32_16x16x32_bf16 v[32:35], v[60:63], v[128:131], v[32:35]
    ds_read_b128 v[156:159], v10 offset:3904
    s_waitcnt lgkmcnt(15)
    v_mfma_f32_16x16x32_bf16 v[32:35], v[64:67], v[124:127], v[32:35]
    ds_read2_b32 v[92:93], v16 offset0:80 offset1:81
    v_mfma_f32_16x16x32_bf16 v[36:39], v[64:67], v[128:131], v[36:39]
    ds_read2_b32 v[94:95], v16 offset0:82 offset1:83
    v_mfma_f32_16x16x32_bf16 v[36:39], v[60:63], v[132:135], v[36:39]
    ds_read_b128 v[160:163], v10 offset:3392
    v_mfma_f32_16x16x32_bf16 v[36:39], v[68:71], v[124:127], v[36:39]
    v_mfma_f32_16x16x32_bf16 v[40:43], v[64:67], v[132:135], v[40:43]
    ds_read2_b32 v[96:97], v16 offset0:208 offset1:209
    v_mfma_f32_16x16x32_bf16 v[40:43], v[68:71], v[128:131], v[40:43]
    ds_read2_b32 v[98:99], v16 offset0:210 offset1:211
    v_mfma_f32_16x16x32_bf16 v[44:47], v[68:71], v[132:135], v[44:47]
    ds_read_b128 v[164:167], v10 offset:2880
    v_mfma_f32_16x16x32_bf16 v[40:43], v[60:63], v[136:139], v[40:43]
    ds_read2_b32 v[100:101], v17 offset0:80 offset1:81
    s_waitcnt lgkmcnt(15)
    v_mfma_f32_16x16x32_bf16 v[40:43], v[72:75], v[124:127], v[40:43]
    v_mfma_f32_16x16x32_bf16 v[44:47], v[64:67], v[136:139], v[44:47]
    ds_read2_b32 v[102:103], v17 offset0:82 offset1:83
    v_mfma_f32_16x16x32_bf16 v[44:47], v[72:75], v[128:131], v[44:47]
    ds_read_b128 v[168:171], v10 offset:2368
    v_mfma_f32_16x16x32_bf16 v[48:51], v[68:71], v[136:139], v[48:51]
    ds_read2_b32 v[104:105], v17 offset0:208 offset1:209
    v_mfma_f32_16x16x32_bf16 v[48:51], v[72:75], v[132:135], v[48:51]
    ds_read2_b32 v[106:107], v17 offset0:210 offset1:211
    v_mfma_f32_16x16x32_bf16 v[52:55], v[72:75], v[136:139], v[52:55]
    v_mfma_f32_16x16x32_bf16 v[44:47], v[60:63], v[140:143], v[44:47]
    ds_read_b128 v[172:175], v10 offset:1856
    v_mfma_f32_16x16x32_bf16 v[44:47], v[76:79], v[124:127], v[44:47]
    ds_read2_b32 v[108:109], v18 offset0:80 offset1:81
    v_mfma_f32_16x16x32_bf16 v[48:51], v[64:67], v[140:143], v[48:51]
    ds_read2_b32 v[110:111], v18 offset0:82 offset1:83
    v_mfma_f32_16x16x32_bf16 v[48:51], v[76:79], v[128:131], v[48:51]
    ds_read_b128 v[176:179], v10 offset:1344
    v_mfma_f32_16x16x32_bf16 v[52:55], v[68:71], v[140:143], v[52:55]
    v_mfma_f32_16x16x32_bf16 v[52:55], v[76:79], v[132:135], v[52:55]
    ds_read2_b32 v[112:113], v18 offset0:208 offset1:209
    v_mfma_f32_16x16x32_bf16 v[56:59], v[72:75], v[140:143], v[56:59]
    ds_read2_b32 v[114:115], v18 offset0:210 offset1:211
    v_mfma_f32_16x16x32_bf16 v[56:59], v[76:79], v[136:139], v[56:59]
    ds_read_b128 v[180:183], v10 offset:832
    v_mfma_f32_16x16x32_bf16 v[48:51], v[60:63], v[144:147], v[48:51]
    ds_read2_b32 v[116:117], v19 offset0:80 offset1:81
    s_waitcnt lgkmcnt(15)
    v_mfma_f32_16x16x32_bf16 v[48:51], v[80:83], v[124:127], v[48:51]
    v_mfma_f32_16x16x32_bf16 v[52:55], v[64:67], v[144:147], v[52:55]
    ds_read2_b32 v[118:119], v19 offset0:82 offset1:83
    v_mfma_f32_16x16x32_bf16 v[52:55], v[80:83], v[128:131], v[52:55]
    ds_read_b128 v[184:187], v10 offset:320
    v_mfma_f32_16x16x32_bf16 v[56:59], v[68:71], v[144:147], v[56:59]
    ds_read2_b32 v[120:121], v19 offset0:208 offset1:209
    v_mfma_f32_16x16x32_bf16 v[56:59], v[80:83], v[132:135], v[56:59]
    ds_read2_b32 v[122:123], v19 offset0:210 offset1:211
    v_mfma_f32_16x16x32_bf16 v[52:55], v[60:63], v[148:151], v[52:55]
    v_mfma_f32_16x16x32_bf16 v[52:55], v[84:87], v[124:127], v[52:55]
    v_mfma_f32_16x16x32_bf16 v[56:59], v[64:67], v[148:151], v[56:59]
    v_mfma_f32_16x16x32_bf16 v[56:59], v[84:87], v[128:131], v[56:59]
    v_mfma_f32_16x16x32_bf16 v[56:59], v[60:63], v[152:155], v[56:59]
    v_mfma_f32_16x16x32_bf16 v[56:59], v[88:91], v[124:127], v[56:59]
    v_mfma_f32_16x16x32_bf16 v[28:31], v[92:95], v[156:159], v[28:31]
    v_mfma_f32_16x16x32_bf16 v[32:35], v[92:95], v[160:163], v[32:35]
    ds_read_b128 v[124:127], v10 offset:3968
    s_waitcnt lgkmcnt(15)
    v_mfma_f32_16x16x32_bf16 v[32:35], v[96:99], v[156:159], v[32:35]
    ds_read2_b32 v[60:61], v16 offset0:96 offset1:97
    v_mfma_f32_16x16x32_bf16 v[36:39], v[96:99], v[160:163], v[36:39]
    ds_read2_b32 v[62:63], v16 offset0:98 offset1:99
    v_mfma_f32_16x16x32_bf16 v[36:39], v[92:95], v[164:167], v[36:39]
    ds_read_b128 v[128:131], v10 offset:3456
    v_mfma_f32_16x16x32_bf16 v[36:39], v[100:103], v[156:159], v[36:39]
    v_mfma_f32_16x16x32_bf16 v[40:43], v[96:99], v[164:167], v[40:43]
    ds_read2_b32 v[64:65], v16 offset0:224 offset1:225
    v_mfma_f32_16x16x32_bf16 v[40:43], v[100:103], v[160:163], v[40:43]
    ds_read2_b32 v[66:67], v16 offset0:226 offset1:227
    v_mfma_f32_16x16x32_bf16 v[44:47], v[100:103], v[164:167], v[44:47]
    ds_read_b128 v[132:135], v10 offset:2944
    v_mfma_f32_16x16x32_bf16 v[40:43], v[92:95], v[168:171], v[40:43]
    ds_read2_b32 v[68:69], v17 offset0:96 offset1:97
    s_waitcnt lgkmcnt(15)
    v_mfma_f32_16x16x32_bf16 v[40:43], v[104:107], v[156:159], v[40:43]
    v_mfma_f32_16x16x32_bf16 v[44:47], v[96:99], v[168:171], v[44:47]
    ds_read2_b32 v[70:71], v17 offset0:98 offset1:99
    v_mfma_f32_16x16x32_bf16 v[44:47], v[104:107], v[160:163], v[44:47]
    ds_read_b128 v[136:139], v10 offset:2432
    v_mfma_f32_16x16x32_bf16 v[48:51], v[100:103], v[168:171], v[48:51]
    ds_read2_b32 v[72:73], v17 offset0:224 offset1:225
    v_mfma_f32_16x16x32_bf16 v[48:51], v[104:107], v[164:167], v[48:51]
    ds_read2_b32 v[74:75], v17 offset0:226 offset1:227
    v_mfma_f32_16x16x32_bf16 v[52:55], v[104:107], v[168:171], v[52:55]
    v_mfma_f32_16x16x32_bf16 v[44:47], v[92:95], v[172:175], v[44:47]
    ds_read_b128 v[140:143], v10 offset:1920
    v_mfma_f32_16x16x32_bf16 v[44:47], v[108:111], v[156:159], v[44:47]
    ds_read2_b32 v[76:77], v18 offset0:96 offset1:97
    v_mfma_f32_16x16x32_bf16 v[48:51], v[96:99], v[172:175], v[48:51]
    ds_read2_b32 v[78:79], v18 offset0:98 offset1:99
    v_mfma_f32_16x16x32_bf16 v[48:51], v[108:111], v[160:163], v[48:51]
    ds_read_b128 v[144:147], v10 offset:1408
    v_mfma_f32_16x16x32_bf16 v[52:55], v[100:103], v[172:175], v[52:55]
    v_mfma_f32_16x16x32_bf16 v[52:55], v[108:111], v[164:167], v[52:55]
    ds_read2_b32 v[80:81], v18 offset0:224 offset1:225
    v_mfma_f32_16x16x32_bf16 v[56:59], v[104:107], v[172:175], v[56:59]
    ds_read2_b32 v[82:83], v18 offset0:226 offset1:227
    v_mfma_f32_16x16x32_bf16 v[56:59], v[108:111], v[168:171], v[56:59]
    ds_read_b128 v[148:151], v10 offset:896
    v_mfma_f32_16x16x32_bf16 v[48:51], v[92:95], v[176:179], v[48:51]
    ds_read2_b32 v[84:85], v19 offset0:96 offset1:97
    s_waitcnt lgkmcnt(15)
    v_mfma_f32_16x16x32_bf16 v[48:51], v[112:115], v[156:159], v[48:51]
    v_mfma_f32_16x16x32_bf16 v[52:55], v[96:99], v[176:179], v[52:55]
    ds_read2_b32 v[86:87], v19 offset0:98 offset1:99
    v_mfma_f32_16x16x32_bf16 v[52:55], v[112:115], v[160:163], v[52:55]
    ds_read_b128 v[152:155], v10 offset:384
    v_mfma_f32_16x16x32_bf16 v[56:59], v[100:103], v[176:179], v[56:59]
    ds_read2_b32 v[88:89], v19 offset0:224 offset1:225
    v_mfma_f32_16x16x32_bf16 v[56:59], v[112:115], v[164:167], v[56:59]
    ds_read2_b32 v[90:91], v19 offset0:226 offset1:227
    v_mfma_f32_16x16x32_bf16 v[52:55], v[92:95], v[180:183], v[52:55]
    v_mfma_f32_16x16x32_bf16 v[52:55], v[116:119], v[156:159], v[52:55]
    v_mfma_f32_16x16x32_bf16 v[56:59], v[96:99], v[180:183], v[56:59]
    v_mfma_f32_16x16x32_bf16 v[56:59], v[116:119], v[160:163], v[56:59]
    v_mfma_f32_16x16x32_bf16 v[56:59], v[92:95], v[184:187], v[56:59]
    v_mfma_f32_16x16x32_bf16 v[56:59], v[120:123], v[156:159], v[56:59]
    v_mfma_f32_16x16x32_bf16 v[28:31], v[60:63], v[124:127], v[28:31]
    v_mfma_f32_16x16x32_bf16 v[32:35], v[60:63], v[128:131], v[32:35]
    ds_read_b128 v[156:159], v10 offset:4032
    s_waitcnt lgkmcnt(15)
    v_mfma_f32_16x16x32_bf16 v[32:35], v[64:67], v[124:127], v[32:35]
    ds_read2_b32 v[92:93], v16 offset0:112 offset1:113
    v_mfma_f32_16x16x32_bf16 v[36:39], v[64:67], v[128:131], v[36:39]
    ds_read2_b32 v[94:95], v16 offset0:114 offset1:115
    v_mfma_f32_16x16x32_bf16 v[36:39], v[60:63], v[132:135], v[36:39]
    ds_read_b128 v[160:163], v10 offset:3520
    v_mfma_f32_16x16x32_bf16 v[36:39], v[68:71], v[124:127], v[36:39]
    v_mfma_f32_16x16x32_bf16 v[40:43], v[64:67], v[132:135], v[40:43]
    ds_read2_b32 v[96:97], v16 offset0:240 offset1:241
    v_mfma_f32_16x16x32_bf16 v[40:43], v[68:71], v[128:131], v[40:43]
    ds_read2_b32 v[98:99], v16 offset0:242 offset1:243
    v_mfma_f32_16x16x32_bf16 v[44:47], v[68:71], v[132:135], v[44:47]
    ds_read_b128 v[164:167], v10 offset:3008
    v_mfma_f32_16x16x32_bf16 v[40:43], v[60:63], v[136:139], v[40:43]
    ds_read2_b32 v[100:101], v17 offset0:112 offset1:113
    s_waitcnt lgkmcnt(15)
    v_mfma_f32_16x16x32_bf16 v[40:43], v[72:75], v[124:127], v[40:43]
    v_mfma_f32_16x16x32_bf16 v[44:47], v[64:67], v[136:139], v[44:47]
    ds_read2_b32 v[102:103], v17 offset0:114 offset1:115
    v_mfma_f32_16x16x32_bf16 v[44:47], v[72:75], v[128:131], v[44:47]
    ds_read_b128 v[168:171], v10 offset:2496
    v_mfma_f32_16x16x32_bf16 v[48:51], v[68:71], v[136:139], v[48:51]
    ds_read2_b32 v[104:105], v17 offset0:240 offset1:241
    v_mfma_f32_16x16x32_bf16 v[48:51], v[72:75], v[132:135], v[48:51]
    ds_read2_b32 v[106:107], v17 offset0:242 offset1:243
    v_mfma_f32_16x16x32_bf16 v[52:55], v[72:75], v[136:139], v[52:55]
    v_mfma_f32_16x16x32_bf16 v[44:47], v[60:63], v[140:143], v[44:47]
    ds_read_b128 v[172:175], v10 offset:1984
    v_mfma_f32_16x16x32_bf16 v[44:47], v[76:79], v[124:127], v[44:47]
    ds_read2_b32 v[108:109], v18 offset0:112 offset1:113
    v_mfma_f32_16x16x32_bf16 v[48:51], v[64:67], v[140:143], v[48:51]
    ds_read2_b32 v[110:111], v18 offset0:114 offset1:115
    v_mfma_f32_16x16x32_bf16 v[48:51], v[76:79], v[128:131], v[48:51]
    ds_read_b128 v[176:179], v10 offset:1472
    v_mfma_f32_16x16x32_bf16 v[52:55], v[68:71], v[140:143], v[52:55]
    v_mfma_f32_16x16x32_bf16 v[52:55], v[76:79], v[132:135], v[52:55]
    ds_read2_b32 v[112:113], v18 offset0:240 offset1:241
    v_mfma_f32_16x16x32_bf16 v[56:59], v[72:75], v[140:143], v[56:59]
    ds_read2_b32 v[114:115], v18 offset0:242 offset1:243
    v_mfma_f32_16x16x32_bf16 v[56:59], v[76:79], v[136:139], v[56:59]
    ds_read_b128 v[180:183], v10 offset:960
    v_mfma_f32_16x16x32_bf16 v[48:51], v[60:63], v[144:147], v[48:51]
    ds_read2_b32 v[116:117], v19 offset0:112 offset1:113
    s_waitcnt lgkmcnt(15)
    v_mfma_f32_16x16x32_bf16 v[48:51], v[80:83], v[124:127], v[48:51]
    v_mfma_f32_16x16x32_bf16 v[52:55], v[64:67], v[144:147], v[52:55]
    ds_read2_b32 v[118:119], v19 offset0:114 offset1:115
    v_mfma_f32_16x16x32_bf16 v[52:55], v[80:83], v[128:131], v[52:55]
    ds_read_b128 v[184:187], v10 offset:448
    v_mfma_f32_16x16x32_bf16 v[56:59], v[68:71], v[144:147], v[56:59]
    ds_read2_b32 v[120:121], v19 offset0:240 offset1:241
    v_mfma_f32_16x16x32_bf16 v[56:59], v[80:83], v[132:135], v[56:59]
    ds_read2_b32 v[122:123], v19 offset0:242 offset1:243
    v_mfma_f32_16x16x32_bf16 v[52:55], v[60:63], v[148:151], v[52:55]
    v_mfma_f32_16x16x32_bf16 v[52:55], v[84:87], v[124:127], v[52:55]
    v_mfma_f32_16x16x32_bf16 v[56:59], v[64:67], v[148:151], v[56:59]
    v_mfma_f32_16x16x32_bf16 v[56:59], v[84:87], v[128:131], v[56:59]
    v_mfma_f32_16x16x32_bf16 v[56:59], v[60:63], v[152:155], v[56:59]
    v_mfma_f32_16x16x32_bf16 v[56:59], v[88:91], v[124:127], v[56:59]
    v_mfma_f32_16x16x32_bf16 v[28:31], v[92:95], v[156:159], v[28:31]
    v_mfma_f32_16x16x32_bf16 v[32:35], v[92:95], v[160:163], v[32:35]
    s_waitcnt lgkmcnt(15)
    v_mfma_f32_16x16x32_bf16 v[32:35], v[96:99], v[156:159], v[32:35]
    v_mfma_f32_16x16x32_bf16 v[36:39], v[92:95], v[164:167], v[36:39]
    v_mfma_f32_16x16x32_bf16 v[36:39], v[96:99], v[160:163], v[36:39]
    v_mfma_f32_16x16x32_bf16 v[36:39], v[100:103], v[156:159], v[36:39]
    s_nop 1
    v_cvt_pk_bf16_f32 v60, v28, v29
    s_waitcnt lgkmcnt(14)
    v_mfma_f32_16x16x32_bf16 v[40:43], v[92:95], v[168:171], v[40:43]
    v_cvt_pk_bf16_f32 v61, v30, v31
    v_mfma_f32_16x16x32_bf16 v[40:43], v[96:99], v[164:167], v[40:43]
    ds_write_b64 v11, v[60:61] offset:4608
    v_mfma_f32_16x16x32_bf16 v[40:43], v[100:103], v[160:163], v[40:43]
    s_waitcnt lgkmcnt(13)
    v_mfma_f32_16x16x32_bf16 v[40:43], v[104:107], v[156:159], v[40:43]
    v_cvt_pk_bf16_f32 v62, v32, v33
    s_waitcnt lgkmcnt(12)
    v_mfma_f32_16x16x32_bf16 v[44:47], v[92:95], v[172:175], v[44:47]
    v_cvt_pk_bf16_f32 v63, v34, v35
    v_mfma_f32_16x16x32_bf16 v[44:47], v[96:99], v[168:171], v[44:47]
    ds_write_b64 v11, v[62:63] offset:5120
    v_mfma_f32_16x16x32_bf16 v[44:47], v[100:103], v[164:167], v[44:47]
    v_mfma_f32_16x16x32_bf16 v[44:47], v[104:107], v[160:163], v[44:47]
    s_waitcnt lgkmcnt(11)
    v_mfma_f32_16x16x32_bf16 v[44:47], v[108:111], v[156:159], v[44:47]
    v_cvt_pk_bf16_f32 v64, v36, v37
    s_waitcnt lgkmcnt(10)
    v_mfma_f32_16x16x32_bf16 v[48:51], v[92:95], v[176:179], v[48:51]
    v_cvt_pk_bf16_f32 v65, v38, v39
    v_mfma_f32_16x16x32_bf16 v[48:51], v[96:99], v[172:175], v[48:51]
    ds_write_b64 v11, v[64:65] offset:5632
    v_mfma_f32_16x16x32_bf16 v[48:51], v[100:103], v[168:171], v[48:51]
    v_mfma_f32_16x16x32_bf16 v[48:51], v[104:107], v[164:167], v[48:51]
    v_mfma_f32_16x16x32_bf16 v[48:51], v[108:111], v[160:163], v[48:51]
    s_waitcnt lgkmcnt(9)
    v_mfma_f32_16x16x32_bf16 v[48:51], v[112:115], v[156:159], v[48:51]
    v_cvt_pk_bf16_f32 v66, v40, v41
    s_waitcnt lgkmcnt(8)
    v_mfma_f32_16x16x32_bf16 v[52:55], v[92:95], v[180:183], v[52:55]
    v_cvt_pk_bf16_f32 v67, v42, v43
    v_mfma_f32_16x16x32_bf16 v[52:55], v[96:99], v[176:179], v[52:55]
    ds_write_b64 v11, v[66:67] offset:6144
    v_mfma_f32_16x16x32_bf16 v[52:55], v[100:103], v[172:175], v[52:55]
    v_mfma_f32_16x16x32_bf16 v[52:55], v[104:107], v[168:171], v[52:55]
    v_mfma_f32_16x16x32_bf16 v[52:55], v[108:111], v[164:167], v[52:55]
    v_mfma_f32_16x16x32_bf16 v[52:55], v[112:115], v[160:163], v[52:55]
    s_waitcnt lgkmcnt(7)
    v_mfma_f32_16x16x32_bf16 v[52:55], v[116:119], v[156:159], v[52:55]
    v_cvt_pk_bf16_f32 v68, v44, v45
    s_waitcnt lgkmcnt(6)
    v_mfma_f32_16x16x32_bf16 v[56:59], v[92:95], v[184:187], v[56:59]
    v_cvt_pk_bf16_f32 v69, v46, v47
    v_mfma_f32_16x16x32_bf16 v[56:59], v[96:99], v[180:183], v[56:59]
    ds_write_b64 v11, v[68:69] offset:6656
    v_mfma_f32_16x16x32_bf16 v[56:59], v[100:103], v[176:179], v[56:59]
    v_mfma_f32_16x16x32_bf16 v[56:59], v[104:107], v[172:175], v[56:59]
    v_mfma_f32_16x16x32_bf16 v[56:59], v[108:111], v[168:171], v[56:59]
    v_mfma_f32_16x16x32_bf16 v[56:59], v[112:115], v[164:167], v[56:59]
    v_mfma_f32_16x16x32_bf16 v[56:59], v[116:119], v[160:163], v[56:59]
    s_waitcnt lgkmcnt(5)
    v_mfma_f32_16x16x32_bf16 v[56:59], v[120:123], v[156:159], v[56:59]
    v_cvt_pk_bf16_f32 v70, v48, v49
    v_cvt_pk_bf16_f32 v71, v50, v51
    ds_write_b64 v11, v[70:71] offset:7168
    v_cvt_pk_bf16_f32 v72, v52, v53
    v_cvt_pk_bf16_f32 v73, v54, v55
    ds_write_b64 v11, v[72:73] offset:7680
    s_nop 1
    v_cvt_pk_bf16_f32 v74, v56, v57
    v_cvt_pk_bf16_f32 v75, v58, v59
    ds_write_b64 v11, v[74:75] offset:8192
    v_mov_b32 v21, s29
    s_lshl_b32 s60, s28, 10
    v_add_u32 v22, s60, v13
    v_lshrrev_b32 v23, 1, v22
    s_lshl_b32 s61, s52, 11
    s_add_u32 s61, s61, 2621440
    s_mov_b32 s62, 0x88888888
    s_mov_b32 s63, 0x88888888
    s_lshl2_add_u32 s30, s28, 62176
    s_mov_b64 exec, 15
    v_mov_b32 v6, s30
    v_lshlrev_b32 v8, 2, v0
    ds_write_b32 v6, v6
    s_mov_b32 s30, 1048576
Llj_67:
    ds_read_b32 v9, v8 offset:62176
    s_sub_u32 s30, s30, 1
    s_cbranch_scc1 Lljd_68
    s_waitcnt lgkmcnt(0)
    v_cmp_eq_u32 vcc, 0, v9
    s_nop 1
    s_cbranch_vccnz Llj_67
Lljd_68:
    s_mov_b64 exec, -1
    ds_read_b128 v[124:127], v12 offset:4608
    ds_read_b128 v[128:131], v12 offset:4864
    ds_read_b128 v[132:135], v12 offset:5120
    ds_read_b128 v[136:139], v12 offset:5376
    ds_read_b32 v20, v22 offset:43404
    s_waitcnt lgkmcnt(4)
    v_cndmask_b32 v127, v127, v21, s[62:63]
    buffer_store_dwordx4 v[124:127], v13, s[44:47], s67 offen offset:0 sc1
    s_waitcnt lgkmcnt(3)
    v_cndmask_b32 v131, v131, v21, s[62:63]
    buffer_store_dwordx4 v[128:131], v13, s[44:47], s67 offen offset:1024 sc1
    s_waitcnt lgkmcnt(2)
    v_cndmask_b32 v135, v135, v21, s[62:63]
    buffer_store_dwordx4 v[132:135], v13, s[44:47], s67 offen offset:2048 sc1
    s_waitcnt lgkmcnt(1)
    v_cndmask_b32 v139, v139, v21, s[62:63]
    buffer_store_dwordx4 v[136:139], v13, s[44:47], s67 offen offset:3072 sc1
    s_waitcnt lgkmcnt(0)
    buffer_store_dwordx2 v[20:21], v23, s[44:47], s61 offen sc1
    s_cmp_eq_u32 s28, 3
    s_cbranch_scc1 L_end3
L_b3:
    s_add_u32 s32, s26, 9961472
    s_addc_u32 s33, s27, 0
    s_mov_b32 s34, 2949120
    s_mov_b32 s35, 0x20000
    s_mov_b32 s40, s22
    s_mov_b32 s41, s23
    s_mov_b32 s42, 5242880
    s_mov_b32 s43, 0x20000
    s_mov_b32 s56, 0
    s_mov_b32 s57, 16384
    s_mov_b32 s58, 32768
    s_mov_b32 s59, 49152
    s_lshl_b32 s60, s71, 9
    s_add_u32 s60, s60, 99328
    s_mov_b32 s62, 5120
    s_mov_b32 s63, 10240
    s_mov_b32 s64, 15360
    s_mov_b32 s65, 2621440
    s_mov_b32 s66, 2625536
    s_mov_b32 s44, 0x88888888
    s_mov_b32 s45, 0x88888888
    v_lshrrev_b32 v112, 16, v237
    v_lshlrev_b32 v112, 13, v112
    v_bfe_u32 v2, v237, 6, 8
    v_lshl_add_u32 v112, v2, 3, v112
    s_waitcnt vmcnt(0)
    v_lshlrev_b32 v56, 16, v240
    v_and_b32 v57, 0xffff0000, v240
    v_lshlrev_b32 v58, 16, v241
    v_and_b32 v59, 0xffff0000, v241
    v_lshlrev_b32 v60, 16, v242
    v_and_b32 v61, 0xffff0000, v242
    v_lshlrev_b32 v62, 16, v243
    v_and_b32 v63, 0xffff0000, v243
    v_lshlrev_b32 v64, 16, v244
    v_and_b32 v65, 0xffff0000, v244
    v_lshlrev_b32 v66, 16, v245
    v_and_b32 v67, 0xffff0000, v245
    v_lshlrev_b32 v68, 16, v246
    v_and_b32 v69, 0xffff0000, v246
    v_lshlrev_b32 v70, 16, v247
    v_and_b32 v71, 0xffff0000, v247
    v_lshlrev_b32 v72, 16, v248
    v_and_b32 v73, 0xffff0000, v248
    v_lshlrev_b32 v74, 16, v249
    v_and_b32 v75, 0xffff0000, v249
    v_lshlrev_b32 v76, 16, v250
    v_and_b32 v77, 0xffff0000, v250
    v_lshlrev_b32 v78, 16, v251
    v_and_b32 v79, 0xffff0000, v251
    v_lshlrev_b32 v80, 16, v252
    v_and_b32 v81, 0xffff0000, v252
    v_lshlrev_b32 v82, 16, v253
    v_and_b32 v83, 0xffff0000, v253
    v_lshlrev_b32 v84, 16, v254
    v_and_b32 v85, 0xffff0000, v254
    v_lshlrev_b32 v86, 16, v255
    v_and_b32 v87, 0xffff0000, v255
    v_lshlrev_b32 v2, 2, v0
    s_mov_b64 exec, 15
    s_mov_b32 s30, 1048576
Llw_69:
    ds_read_b32 v3, v2 offset:62240
    s_waitcnt lgkmcnt(0)
    v_cmp_eq_u32 vcc, 0, v3
    s_sub_u32 s30, s30, 1
    s_cbranch_scc1 Llwd_70
    s_cbranch_vccz Llwd_70
    s_sleep 2
    s_branch Llw_69
Llwd_70:
    s_mov_b64 exec, -1
    s_mov_b64 s[46:47], s[72:73]
    s_mov_b32 s75, 131072
Lyl_71:
    s_mov_b64 exec, s[46:47]
    buffer_load_dwordx4 v[8:11], v237, s[32:35], s56 offen sc1
    buffer_load_dwordx4 v[12:15], v237, s[32:35], s57 offen sc1
    buffer_load_dwordx4 v[16:19], v237, s[32:35], s58 offen sc1
    buffer_load_dwordx4 v[20:23], v237, s[32:35], s59 offen sc1
    s_and_b64 exec, exec, s[44:45]
    buffer_load_dwordx2 v[104:105], v112, s[32:35], s65 offen offset:0 sc1
    buffer_load_dwordx2 v[106:107], v112, s[32:35], s65 offen offset:2048 sc1
    buffer_load_dwordx2 v[108:109], v112, s[32:35], s66 offen offset:0 sc1
    buffer_load_dwordx2 v[110:111], v112, s[32:35], s66 offen offset:2048 sc1
    s_waitcnt vmcnt(0)
    v_min3_u32 v2, v11, v15, v19
    v_max3_u32 v3, v11, v15, v19
    v_min3_u32 v2, v2, v23, v105
    v_max3_u32 v3, v3, v23, v105
    v_min3_u32 v2, v2, v107, v109
    v_max3_u32 v3, v3, v107, v109
    v_min3_u32 v2, v2, v111, s29
    v_max3_u32 v3, v3, v111, s29
    v_cmp_ne_u32 vcc, v2, v3
    s_sub_u32 s75, s75, 1
    s_cbranch_scc1 Lyld_72
    s_cbranch_vccz Lyld_72
    s_lshr_b64 s[46:47], vcc, 1
    s_or_b64 s[46:47], s[46:47], vcc
    s_lshr_b64 vcc, s[46:47], 2
    s_or_b64 s[46:47], s[46:47], vcc
    s_sleep 3
    s_branch Lyl_71
Lyld_72:
    s_mov_b64 exec, s[44:45]
    v_mov_b32 v11, v104
    v_mov_b32 v15, v106
    v_mov_b32 v19, v108
    v_mov_b32 v23, v110
    s_mov_b64 exec, s[72:73]
    v_lshlrev_b32 v24, 16, v8
    v_lshlrev_b32 v25, 16, v12
    v_lshlrev_b32 v26, 16, v16
    v_lshlrev_b32 v27, 16, v20
    v_pk_mul_f32 v[56:57], v[56:57], v[24:25]
    v_cvt_pk_bf16_f32 v88, v56, v57
    v_pk_mul_f32 v[58:59], v[58:59], v[26:27]
    v_cvt_pk_bf16_f32 v89, v58, v59
    buffer_store_dwordx2 v[88:89], v238, s[40:43], 0 offen offset:1280 nt
    v_and_b32 v28, 0xffff0000, v8
    v_and_b32 v29, 0xffff0000, v12
    v_and_b32 v30, 0xffff0000, v16
    v_and_b32 v31, 0xffff0000, v20
    v_pk_mul_f32 v[60:61], v[60:61], v[28:29]
    v_cvt_pk_bf16_f32 v90, v60, v61
    v_pk_mul_f32 v[62:63], v[62:63], v[30:31]
    v_cvt_pk_bf16_f32 v91, v62, v63
    buffer_store_dwordx2 v[90:91], v238, s[40:43], 0 offen offset:3840 nt
    v_lshlrev_b32 v32, 16, v9
    v_lshlrev_b32 v33, 16, v13
    v_lshlrev_b32 v34, 16, v17
    v_lshlrev_b32 v35, 16, v21
    v_pk_mul_f32 v[64:65], v[64:65], v[32:33]
    v_cvt_pk_bf16_f32 v92, v64, v65
    v_pk_mul_f32 v[66:67], v[66:67], v[34:35]
    v_cvt_pk_bf16_f32 v93, v66, v67
    buffer_store_dwordx2 v[92:93], v238, s[40:43], s62 offen offset:1280 nt
    v_and_b32 v36, 0xffff0000, v9
    v_and_b32 v37, 0xffff0000, v13
    v_and_b32 v38, 0xffff0000, v17
    v_and_b32 v39, 0xffff0000, v21
    v_pk_mul_f32 v[68:69], v[68:69], v[36:37]
    v_cvt_pk_bf16_f32 v94, v68, v69
    v_pk_mul_f32 v[70:71], v[70:71], v[38:39]
    v_cvt_pk_bf16_f32 v95, v70, v71
    buffer_store_dwordx2 v[94:95], v238, s[40:43], s62 offen offset:3840 nt
    v_lshlrev_b32 v40, 16, v10
    v_lshlrev_b32 v41, 16, v14
    v_lshlrev_b32 v42, 16, v18
    v_lshlrev_b32 v43, 16, v22
    v_pk_mul_f32 v[72:73], v[72:73], v[40:41]
    v_cvt_pk_bf16_f32 v96, v72, v73
    v_pk_mul_f32 v[74:75], v[74:75], v[42:43]
    v_cvt_pk_bf16_f32 v97, v74, v75
    buffer_store_dwordx2 v[96:97], v238, s[40:43], s63 offen offset:1280 nt
    v_and_b32 v44, 0xffff0000, v10
    v_and_b32 v45, 0xffff0000, v14
    v_and_b32 v46, 0xffff0000, v18
    v_and_b32 v47, 0xffff0000, v22
    v_pk_mul_f32 v[76:77], v[76:77], v[44:45]
    v_cvt_pk_bf16_f32 v98, v76, v77
    v_pk_mul_f32 v[78:79], v[78:79], v[46:47]
    v_cvt_pk_bf16_f32 v99, v78, v79
    buffer_store_dwordx2 v[98:99], v238, s[40:43], s63 offen offset:3840 nt
    v_lshlrev_b32 v48, 16, v11
    v_lshlrev_b32 v49, 16, v15
    v_lshlrev_b32 v50, 16, v19
    v_lshlrev_b32 v51, 16, v23
    v_pk_mul_f32 v[80:81], v[80:81], v[48:49]
    v_cvt_pk_bf16_f32 v100, v80, v81
    v_pk_mul_f32 v[82:83], v[82:83], v[50:51]
    v_cvt_pk_bf16_f32 v101, v82, v83
    buffer_store_dwordx2 v[100:101], v238, s[40:43], s64 offen offset:1280 nt
    v_and_b32 v52, 0xffff0000, v11
    v_and_b32 v53, 0xffff0000, v15
    v_and_b32 v54, 0xffff0000, v19
    v_and_b32 v55, 0xffff0000, v23
    v_pk_mul_f32 v[84:85], v[84:85], v[52:53]
    v_cvt_pk_bf16_f32 v102, v84, v85
    v_pk_mul_f32 v[86:87], v[86:87], v[54:55]
    v_cvt_pk_bf16_f32 v103, v86, v87
    buffer_store_dwordx2 v[102:103], v238, s[40:43], s64 offen offset:3840 nt
    s_mov_b64 exec, -1
    s_endpgm
L_end3:
    s_endpgm
.p2align 6
L_a3:
    v_and_b32 v2, 15, v0
    v_lshrrev_b32 v3, 4, v0
    s_and_b32 s54, s31, 1
    s_lshr_b32 s55, s31, 1
    s_mul_i32 s55, s55, 48
    v_cvt_f32_u32 v13, s54
    v_mov_b32 v28, 0x80000000
    v_add_u32 v6, 0, v3
    v_mul_u32_u24 v7, 11, v6
    v_lshrrev_b32 v7, 5, v7
    v_mul_u32_u24 v16, 3, v7
    v_sub_u32 v6, v6, v16
    v_lshlrev_b32 v6, 2, v6
    v_cvt_f32_u32 v20, v6
    v_cvt_f32_u32 v24, v7
    v_add_u32 v6, 4, v3
    v_mul_u32_u24 v7, 11, v6
    v_lshrrev_b32 v7, 5, v7
    v_mul_u32_u24 v16, 3, v7
    v_sub_u32 v6, v6, v16
    v_lshlrev_b32 v6, 2, v6
    v_cvt_f32_u32 v21, v6
    v_cvt_f32_u32 v25, v7
    v_add_u32 v6, 8, v3
    v_mul_u32_u24 v7, 11, v6
    v_lshrrev_b32 v7, 5, v7
    v_mul_u32_u24 v16, 3, v7
    v_sub_u32 v6, v6, v16
    v_lshlrev_b32 v6, 2, v6
    v_cvt_f32_u32 v22, v6
    v_cvt_f32_u32 v26, v7
    v_add_u32 v4, s55, v2
    v_mul_u32_u24 v5, 205, v4
    v_lshrrev_b32 v5, 12, v5
    v_mul_u32_u24 v6, 1309440, v5
    v_lshl_add_u32 v6, v4, 6, v6
    v_lshl_add_u32 v143, v3, 4, v6
    v_cvt_f32_u32 v10, v4
    v_mul_f32 v10, 0x3d4ccccd, v10
    v_cvt_f32_u32 v11, v5
    v_fma_f32 v11, 2.0, v11, v13
    v_mul_f32 v11, 0x3e000000, v11
    v_mul_f32 v16, v24, v11
    v_fmac_f32 v16, v20, v10
    v_cos_f32 v18, v16
    v_sin_f32 v19, v16
    v_add_f32 v16, v16, v10
    v_cvt_pk_bf16_f32 v216, v18, -v19
    v_cos_f32 v18, v16
    v_sin_f32 v19, v16
    v_add_f32 v16, v16, v10
    v_cvt_pk_bf16_f32 v217, v18, -v19
    v_cos_f32 v18, v16
    v_sin_f32 v19, v16
    v_add_f32 v16, v16, v10
    v_cvt_pk_bf16_f32 v218, v18, -v19
    v_cos_f32 v18, v16
    v_sin_f32 v19, v16
    s_nop 0
    v_cvt_pk_bf16_f32 v219, v18, -v19
    v_mul_f32 v16, v25, v11
    v_fmac_f32 v16, v21, v10
    v_cos_f32 v18, v16
    v_sin_f32 v19, v16
    v_add_f32 v16, v16, v10
    v_cvt_pk_bf16_f32 v220, v18, -v19
    v_cos_f32 v18, v16
    v_sin_f32 v19, v16
    v_add_f32 v16, v16, v10
    v_cvt_pk_bf16_f32 v221, v18, -v19
    v_cos_f32 v18, v16
    v_sin_f32 v19, v16
    v_add_f32 v16, v16, v10
    v_cvt_pk_bf16_f32 v222, v18, -v19
    v_cos_f32 v18, v16
    v_sin_f32 v19, v16
    s_nop 0
    v_cvt_pk_bf16_f32 v223, v18, -v19
    v_mul_f32 v16, v26, v11
    v_fmac_f32 v16, v22, v10
    v_cos_f32 v18, v16
    v_sin_f32 v19, v16
    v_add_f32 v16, v16, v10
    v_cvt_pk_bf16_f32 v224, v18, -v19
    v_cos_f32 v18, v16
    v_sin_f32 v19, v16
    v_add_f32 v16, v16, v10
    v_cvt_pk_bf16_f32 v225, v18, -v19
    v_cos_f32 v18, v16
    v_sin_f32 v19, v16
    v_add_f32 v16, v16, v10
    v_cvt_pk_bf16_f32 v226, v18, -v19
    v_cos_f32 v18, v16
    v_sin_f32 v19, v16
    s_nop 0
    v_cvt_pk_bf16_f32 v227, v18, -v19
    v_add_u32 v4, s55, v2
    v_add_u32 v4, 16, v4
    v_mul_u32_u24 v5, 205, v4
    v_lshrrev_b32 v5, 12, v5
    v_mul_u32_u24 v6, 1309440, v5
    v_lshl_add_u32 v6, v4, 6, v6
    v_lshl_add_u32 v144, v3, 4, v6
    v_cvt_f32_u32 v10, v4
    v_mul_f32 v10, 0x3d4ccccd, v10
    v_cvt_f32_u32 v11, v5
    v_fma_f32 v11, 2.0, v11, v13
    v_mul_f32 v11, 0x3e000000, v11
    v_mul_f32 v16, v24, v11
    v_fmac_f32 v16, v20, v10
    v_cos_f32 v18, v16
    v_sin_f32 v19, v16
    v_add_f32 v16, v16, v10
    v_cvt_pk_bf16_f32 v228, v18, -v19
    v_cos_f32 v18, v16
    v_sin_f32 v19, v16
    v_add_f32 v16, v16, v10
    v_cvt_pk_bf16_f32 v229, v18, -v19
    v_cos_f32 v18, v16
    v_sin_f32 v19, v16
    v_add_f32 v16, v16, v10
    v_cvt_pk_bf16_f32 v230, v18, -v19
    v_cos_f32 v18, v16
    v_sin_f32 v19, v16
    s_nop 0
    v_cvt_pk_bf16_f32 v231, v18, -v19
    v_mul_f32 v16, v25, v11
    v_fmac_f32 v16, v21, v10
    v_cos_f32 v18, v16
    v_sin_f32 v19, v16
    v_add_f32 v16, v16, v10
    v_cvt_pk_bf16_f32 v232, v18, -v19
    v_cos_f32 v18, v16
    v_sin_f32 v19, v16
    v_add_f32 v16, v16, v10
    v_cvt_pk_bf16_f32 v233, v18, -v19
    v_cos_f32 v18, v16
    v_sin_f32 v19, v16
    v_add_f32 v16, v16, v10
    v_cvt_pk_bf16_f32 v234, v18, -v19
    v_cos_f32 v18, v16
    v_sin_f32 v19, v16
    s_nop 0
    v_cvt_pk_bf16_f32 v235, v18, -v19
    v_mul_f32 v16, v26, v11
    v_fmac_f32 v16, v22, v10
    v_cos_f32 v18, v16
    v_sin_f32 v19, v16
    v_add_f32 v16, v16, v10
    v_cvt_pk_bf16_f32 v236, v18, -v19
    v_cos_f32 v18, v16
    v_sin_f32 v19, v16
    v_add_f32 v16, v16, v10
    v_cvt_pk_bf16_f32 v237, v18, -v19
    v_cos_f32 v18, v16
    v_sin_f32 v19, v16
    v_add_f32 v16, v16, v10
    v_cvt_pk_bf16_f32 v238, v18, -v19
    v_cos_f32 v18, v16
    v_sin_f32 v19, v16
    s_nop 0
    v_cvt_pk_bf16_f32 v239, v18, -v19
    v_add_u32 v4, s55, v2
    v_add_u32 v4, 32, v4
    v_mul_u32_u24 v5, 205, v4
    v_lshrrev_b32 v5, 12, v5
    v_mul_u32_u24 v6, 1309440, v5
    v_lshl_add_u32 v6, v4, 6, v6
    v_lshl_add_u32 v145, v3, 4, v6
    s_cmp_lt_u32 s31, 2
    s_cbranch_scc1 Lt3_73x
    v_mov_b32 v145, v28
    s_branch Lt3_73
Lt3_73x:
    v_cvt_f32_u32 v10, v4
    v_mul_f32 v10, 0x3d4ccccd, v10
    v_cvt_f32_u32 v11, v5
    v_fma_f32 v11, 2.0, v11, v13
    v_mul_f32 v11, 0x3e000000, v11
    v_mul_f32 v16, v24, v11
    v_fmac_f32 v16, v20, v10
    v_cos_f32 v18, v16
    v_sin_f32 v19, v16
    v_add_f32 v16, v16, v10
    v_cvt_pk_bf16_f32 v240, v18, -v19
    v_cos_f32 v18, v16
    v_sin_f32 v19, v16
    v_add_f32 v16, v16, v10
    v_cvt_pk_bf16_f32 v241, v18, -v19
    v_cos_f32 v18, v16
    v_sin_f32 v19, v16
    v_add_f32 v16, v16, v10
    v_cvt_pk_bf16_f32 v242, v18, -v19
    v_cos_f32 v18, v16
    v_sin_f32 v19, v16
    s_nop 0
    v_cvt_pk_bf16_f32 v243, v18, -v19
    v_mul_f32 v16, v25, v11
    v_fmac_f32 v16, v21, v10
    v_cos_f32 v18, v16
    v_sin_f32 v19, v16
    v_add_f32 v16, v16, v10
    v_cvt_pk_bf16_f32 v244, v18, -v19
    v_cos_f32 v18, v16
    v_sin_f32 v19, v16
    v_add_f32 v16, v16, v10
    v_cvt_pk_bf16_f32 v245, v18, -v19
    v_cos_f32 v18, v16
    v_sin_f32 v19, v16
    v_add_f32 v16, v16, v10
    v_cvt_pk_bf16_f32 v246, v18, -v19
    v_cos_f32 v18, v16
    v_sin_f32 v19, v16
    s_nop 0
    v_cvt_pk_bf16_f32 v247, v18, -v19
    v_mul_f32 v16, v26, v11
    v_fmac_f32 v16, v22, v10
    v_cos_f32 v18, v16
    v_sin_f32 v19, v16
    v_add_f32 v16, v16, v10
    v_cvt_pk_bf16_f32 v248, v18, -v19
    v_cos_f32 v18, v16
    v_sin_f32 v19, v16
    v_add_f32 v16, v16, v10
    v_cvt_pk_bf16_f32 v249, v18, -v19
    v_cos_f32 v18, v16
    v_sin_f32 v19, v16
    v_add_f32 v16, v16, v10
    v_cvt_pk_bf16_f32 v250, v18, -v19
    v_cos_f32 v18, v16
    v_sin_f32 v19, v16
    s_nop 0
    v_cvt_pk_bf16_f32 v251, v18, -v19
Lt3_73:
    s_add_u32 s32, s26, 6815744
    s_addc_u32 s33, s27, 0
    s_mov_b32 s34, 2883584
    s_mov_b32 s35, 0x20000
    s_mov_b32 s36, s22
    s_mov_b32 s37, s23
    s_mov_b32 s38, 5242880
    s_mov_b32 s39, 0x20000
    s_mul_i32 s52, s2, 11264
    s_mul_i32 s53, s31, 2816
    s_add_u32 s52, s52, s53
    s_mul_i32 s53, s31, 2688
    s_add_u32 s53, s53, 63104
    s_and_b32 s54, s31, 1
    s_lshl_b32 s54, s54, 8
    s_add_u32 s54, s54, s2
    s_mul_i32 s54, s54, 2560
    s_mov_b32 s79, 1344
    v_mov_b32 v8, 0
    v_mov_b32 v9, 0
    v_mov_b32 v10, 0
    v_mov_b32 v11, 0
    v_mov_b32 v12, 0
    v_mov_b32 v13, 0
    v_mov_b32 v14, 0
    v_mov_b32 v15, 0
    v_mov_b32 v16, 0
    v_mov_b32 v17, 0
    v_mov_b32 v18, 0
    v_mov_b32 v19, 0
    v_mov_b32 v20, 0
    v_mov_b32 v21, 0
    v_mov_b32 v22, 0
    v_mov_b32 v23, 0
    v_add_u32 v2, 0, v0
    v_mov_b32 v3, 0
    v_lshrrev_b32 v4, 2, v2
    v_lshlrev_b32 v120, 2, v2
    v_sub_u32 v120, v120, v4
    v_lshlrev_b32 v120, 2, v120
    v_mad_u32_u24 v120, v3, s79, v120
    v_add_u32 v120, s53, v120
    v_add_u32 v2, 64, v0
    v_cmp_le_u32 vcc, 88, v2
    s_nop 1
    v_cndmask_b32 v3, 0, 1, vcc
    v_mul_u32_u24 v121, 88, v3
    v_sub_u32 v2, v2, v121
    v_lshrrev_b32 v4, 2, v2
    v_lshlrev_b32 v121, 2, v2
    v_sub_u32 v121, v121, v4
    v_lshlrev_b32 v121, 2, v121
    v_mad_u32_u24 v121, v3, s79, v121
    v_add_u32 v121, s53, v121
    v_add_u32 v2, 128, v0
    v_mov_b32 v3, 1
    v_subrev_u32 v2, 88, v2
    v_lshrrev_b32 v4, 2, v2
    v_lshlrev_b32 v122, 2, v2
    v_sub_u32 v122, v122, v4
    v_lshlrev_b32 v122, 2, v122
    v_mad_u32_u24 v122, v3, s79, v122
    v_add_u32 v122, s53, v122
    s_lshl_b32 s71, s31, 8
    s_add_u32 s71, s71, 98304
    v_lshlrev_b32 v2, 7, v0
    s_mov_b32 s30, 131072
    s_mov_b64 exec, 3
Lpoll_74:
    buffer_load_dword v3, v2, s[48:51], s71 offen sc1
    s_waitcnt vmcnt(0)
    v_cmp_ne_u32 vcc, s29, v3
    s_sub_u32 s30, s30, 1
    s_cbranch_scc1 Lpolld_75
    s_and_b64 exec, exec, vcc
    s_cbranch_scc0 Lpolld_75
    s_sleep 1
    s_branch Lpoll_74
Lpolld_75:
    s_mov_b64 exec, -1
    s_setprio 2
    s_mov_b32 s75, 131072
    s_mov_b32 s44, 0x88888888
    s_mov_b32 s45, 0x88888888
    s_mov_b64 s[90:91], -1
    s_mov_b64 s[92:93], -1
    s_bfm_b64 s[94:95], 48, 0
Llt_76:
    s_mov_b64 exec, s[90:91]
    s_cbranch_execz Lls_79
    buffer_load_dwordx4 v[72:75], v140, s[32:35], s52 offen offset:0 sc1
Lls_79:
    s_mov_b64 exec, s[92:93]
    s_cbranch_execz Lls_80
    buffer_load_dwordx4 v[76:79], v140, s[32:35], s52 offen offset:1024 sc1
Lls_80:
    s_mov_b64 exec, s[94:95]
    s_cbranch_execz Lls_81
    buffer_load_dwordx4 v[80:83], v140, s[32:35], s52 offen offset:2048 sc1
Lls_81:
Llti_78:
    s_mov_b64 exec, s[44:45]
    s_mov_b64 s[46:47], 0
    s_waitcnt vmcnt(0)
    v_cmp_ne_u32 vcc, s29, v75
    s_nop 1
    s_and_b64 s[90:91], s[90:91], vcc
    s_lshr_b64 vcc, s[90:91], 1
    s_or_b64 s[90:91], s[90:91], vcc
    s_lshr_b64 vcc, s[90:91], 2
    s_or_b64 s[90:91], s[90:91], vcc
    s_or_b64 s[46:47], s[46:47], s[90:91]
    v_cmp_ne_u32 vcc, s29, v79
    s_nop 1
    s_and_b64 s[92:93], s[92:93], vcc
    s_lshr_b64 vcc, s[92:93], 1
    s_or_b64 s[92:93], s[92:93], vcc
    s_lshr_b64 vcc, s[92:93], 2
    s_or_b64 s[92:93], s[92:93], vcc
    s_or_b64 s[46:47], s[46:47], s[92:93]
    v_cmp_ne_u32 vcc, s29, v83
    s_nop 1
    s_and_b64 s[94:95], s[94:95], vcc
    s_lshr_b64 vcc, s[94:95], 1
    s_or_b64 s[94:95], s[94:95], vcc
    s_lshr_b64 vcc, s[94:95], 2
    s_or_b64 s[94:95], s[94:95], vcc
    s_or_b64 s[46:47], s[46:47], s[94:95]
    s_cbranch_scc0 Lltd_77
    s_sub_u32 s75, s75, 1
    s_cbranch_scc1 Lltd_77
    s_sleep 2
    s_branch Llt_76
Lltd_77:
    s_mov_b64 exec, -1
    ds_write2_b32 v120, v72, v73 offset0:0 offset1:1
    ds_write_b32 v120, v74 offset:8
    ds_write2_b32 v121, v76, v77 offset0:0 offset1:1
    ds_write_b32 v121, v78 offset:8
    s_mov_b32 exec_hi, 0xffff
    ds_write2_b32 v122, v80, v81 offset0:0 offset1:1
    ds_write_b32 v122, v82 offset:8
    s_mov_b32 exec_lo, 0x77777777
    s_mov_b32 exec_hi, 0x7777
    ds_write_b32 v122, v83 offset:12
    s_mov_b32 exec_hi, 0x77777777
    ds_write_b32 v120, v75 offset:12
    ds_write_b32 v121, v79 offset:12
    s_mov_b64 exec, -1
    s_lshl2_add_u32 s30, s31, 62240
    s_mov_b64 exec, 15
    v_mov_b32 v2, s30
    v_lshlrev_b32 v4, 2, v0
    ds_write_b32 v2, v2
    s_mov_b32 s30, 1048576
Llj_82:
    ds_read_b32 v5, v4 offset:62240
    s_sub_u32 s30, s30, 1
    s_cbranch_scc1 Lljd_83
    s_waitcnt lgkmcnt(0)
    v_cmp_eq_u32 vcc, 0, v5
    s_nop 1
    s_cbranch_vccnz Llj_82
Lljd_83:
    s_mov_b64 exec, -1
    s_mov_b32 exec_lo, 0x07ff07ff
    s_mov_b32 exec_hi, 0x07ff07ff
    ds_read_b32 v8, v146 offset:0
    ds_read_b32 v9, v146 offset:80
    ds_read_b32 v10, v146 offset:160
    ds_read_b32 v11, v146 offset:240
    ds_read_b32 v16, v146 offset:5376
    ds_read_b32 v17, v146 offset:5456
    ds_read_b32 v18, v146 offset:5536
    ds_read_b32 v19, v146 offset:5616
    s_mov_b32 exec_lo, 0x03fe03ff
    s_mov_b32 exec_hi, 0x03fe03fe
    ds_read_b32 v12, v147 offset:240
    ds_read_b32 v20, v148 offset:240
    s_mov_b32 exec_lo, 0x03fe03fe
    ds_read_b32 v13, v147 offset:160
    ds_read_b32 v14, v147 offset:80
    ds_read_b32 v15, v147 offset:0
    ds_read_b32 v21, v148 offset:160
    ds_read_b32 v22, v148 offset:80
    ds_read_b32 v23, v148 offset:0
    s_mov_b64 exec, -1
    s_waitcnt lgkmcnt(12)
    v_mfma_f32_16x16x32_bf16 v[24:27], v[8:11], v[152:155], 0
    v_mfma_f32_16x16x32_bf16 v[28:31], v[8:11], v[160:163], 0
    s_waitcnt lgkmcnt(8)
    v_mfma_f32_16x16x32_bf16 v[32:35], v[16:19], v[152:155], 0
    v_mfma_f32_16x16x32_bf16 v[36:39], v[16:19], v[160:163], 0
    v_mfma_f32_16x16x32_bf16 v[40:43], v[8:11], v[168:171], 0
    v_mfma_f32_16x16x32_bf16 v[44:47], v[8:11], v[176:179], 0
    v_mfma_f32_16x16x32_bf16 v[48:51], v[16:19], v[168:171], 0
    v_mfma_f32_16x16x32_bf16 v[52:55], v[16:19], v[176:179], 0
    s_waitcnt lgkmcnt(3)
    v_mfma_f32_16x16x32_bf16 v[24:27], v[12:15], v[156:159], v[24:27]
    v_mfma_f32_16x16x32_bf16 v[28:31], v[12:15], v[164:167], v[28:31]
    s_waitcnt lgkmcnt(0)
    v_mfma_f32_16x16x32_bf16 v[32:35], v[20:23], v[156:159], v[32:35]
    v_mfma_f32_16x16x32_bf16 v[36:39], v[20:23], v[164:167], v[36:39]
    v_mfma_f32_16x16x32_bf16 v[40:43], v[12:15], v[172:175], v[40:43]
    v_mfma_f32_16x16x32_bf16 v[44:47], v[12:15], v[180:183], v[44:47]
    v_mfma_f32_16x16x32_bf16 v[48:51], v[20:23], v[172:175], v[48:51]
    v_mfma_f32_16x16x32_bf16 v[52:55], v[20:23], v[180:183], v[52:55]
    v_pk_mul_f32 v[96:97], v[24:25], v[184:185]
    v_pk_mul_f32 v[100:101], v[28:29], v[184:185]
    v_pk_mul_f32 v[98:99], v[26:27], v[186:187]
    v_pk_mul_f32 v[102:103], v[30:31], v[186:187]
    v_pk_fma_f32 v[96:97], v[28:29], v[188:189], v[96:97] neg_lo:[1,0,0] neg_hi:[1,0,0]
    v_pk_fma_f32 v[100:101], v[24:25], v[188:189], v[100:101]
    v_pk_fma_f32 v[98:99], v[30:31], v[190:191], v[98:99] neg_lo:[1,0,0] neg_hi:[1,0,0]
    v_pk_fma_f32 v[102:103], v[26:27], v[190:191], v[102:103]
    v_pk_fma_f32 v[104:105], v[32:33], v[200:201], v[96:97]
    v_pk_fma_f32 v[108:109], v[36:37], v[200:201], v[100:101]
    v_pk_fma_f32 v[106:107], v[34:35], v[202:203], v[98:99]
    v_pk_fma_f32 v[110:111], v[38:39], v[202:203], v[102:103]
    v_pk_fma_f32 v[104:105], v[36:37], v[204:205], v[104:105] neg_lo:[1,0,0] neg_hi:[1,0,0]
    v_pk_fma_f32 v[108:109], v[32:33], v[204:205], v[108:109]
    v_pk_fma_f32 v[106:107], v[38:39], v[206:207], v[106:107] neg_lo:[1,0,0] neg_hi:[1,0,0]
    v_pk_fma_f32 v[110:111], v[34:35], v[206:207], v[110:111]
    v_cvt_pk_bf16_f32 v56, v104, v108
    v_cvt_pk_bf16_f32 v57, v105, v109
    v_cvt_pk_bf16_f32 v58, v106, v110
    v_cvt_pk_bf16_f32 v59, v107, v111
    v_pk_fma_f32 v[96:97], v[96:97], 2.0, v[104:105] op_sel_hi:[1,0,1] neg_lo:[0,0,1] neg_hi:[0,0,1]
    v_pk_fma_f32 v[100:101], v[100:101], 2.0, v[108:109] op_sel_hi:[1,0,1] neg_lo:[0,0,1] neg_hi:[0,0,1]
    v_pk_fma_f32 v[98:99], v[98:99], 2.0, v[106:107] op_sel_hi:[1,0,1] neg_lo:[0,0,1] neg_hi:[0,0,1]
    v_pk_fma_f32 v[102:103], v[102:103], 2.0, v[110:111] op_sel_hi:[1,0,1] neg_lo:[0,0,1] neg_hi:[0,0,1]
    v_cvt_pk_bf16_f32 v64, v96, v100
    v_cvt_pk_bf16_f32 v65, v97, v101
    v_cvt_pk_bf16_f32 v66, v98, v102
    v_cvt_pk_bf16_f32 v67, v99, v103
    s_mov_b32 exec_hi, 0xffff
    ds_write_b128 v149, v[56:59] offset:0
    ds_write_b128 v149, v[64:67] offset:6144
    s_mov_b64 exec, -1
    v_pk_mul_f32 v[96:97], v[40:41], v[192:193]
    v_pk_mul_f32 v[100:101], v[44:45], v[192:193]
    v_pk_mul_f32 v[98:99], v[42:43], v[194:195]
    v_pk_mul_f32 v[102:103], v[46:47], v[194:195]
    v_pk_fma_f32 v[96:97], v[44:45], v[196:197], v[96:97] neg_lo:[1,0,0] neg_hi:[1,0,0]
    v_pk_fma_f32 v[100:101], v[40:41], v[196:197], v[100:101]
    v_pk_fma_f32 v[98:99], v[46:47], v[198:199], v[98:99] neg_lo:[1,0,0] neg_hi:[1,0,0]
    v_pk_fma_f32 v[102:103], v[42:43], v[198:199], v[102:103]
    v_pk_fma_f32 v[104:105], v[48:49], v[208:209], v[96:97]
    v_pk_fma_f32 v[108:109], v[52:53], v[208:209], v[100:101]
    v_pk_fma_f32 v[106:107], v[50:51], v[210:211], v[98:99]
    v_pk_fma_f32 v[110:111], v[54:55], v[210:211], v[102:103]
    v_pk_fma_f32 v[104:105], v[52:53], v[212:213], v[104:105] neg_lo:[1,0,0] neg_hi:[1,0,0]
    v_pk_fma_f32 v[108:109], v[48:49], v[212:213], v[108:109]
    v_pk_fma_f32 v[106:107], v[54:55], v[214:215], v[106:107] neg_lo:[1,0,0] neg_hi:[1,0,0]
    v_pk_fma_f32 v[110:111], v[50:51], v[214:215], v[110:111]
    v_cvt_pk_bf16_f32 v60, v104, v108
    v_cvt_pk_bf16_f32 v61, v105, v109
    v_cvt_pk_bf16_f32 v62, v106, v110
    v_cvt_pk_bf16_f32 v63, v107, v111
    v_pk_fma_f32 v[96:97], v[96:97], 2.0, v[104:105] op_sel_hi:[1,0,1] neg_lo:[0,0,1] neg_hi:[0,0,1]
    v_pk_fma_f32 v[100:101], v[100:101], 2.0, v[108:109] op_sel_hi:[1,0,1] neg_lo:[0,0,1] neg_hi:[0,0,1]
    v_pk_fma_f32 v[98:99], v[98:99], 2.0, v[106:107] op_sel_hi:[1,0,1] neg_lo:[0,0,1] neg_hi:[0,0,1]
    v_pk_fma_f32 v[102:103], v[102:103], 2.0, v[110:111] op_sel_hi:[1,0,1] neg_lo:[0,0,1] neg_hi:[0,0,1]
    v_cvt_pk_bf16_f32 v68, v96, v100
    v_cvt_pk_bf16_f32 v69, v97, v101
    v_cvt_pk_bf16_f32 v70, v98, v102
    v_cvt_pk_bf16_f32 v71, v99, v103
    s_mov_b32 exec_hi, 0xffff
    ds_write_b128 v149, v[60:63] offset:3072
    ds_write_b128 v149, v[68:71] offset:9216
    s_mov_b64 exec, -1
    s_lshl2_add_u32 s30, s31, 62272
    s_mov_b64 exec, 15
    v_mov_b32 v2, s30
    v_lshlrev_b32 v4, 2, v0
    ds_write_b32 v2, v2
    s_mov_b32 s30, 1048576
Llj_84:
    ds_read_b32 v5, v4 offset:62272
    s_sub_u32 s30, s30, 1
    s_cbranch_scc1 Lljd_85
    s_waitcnt lgkmcnt(0)
    v_cmp_eq_u32 vcc, 0, v5
    s_nop 1
    s_cbranch_vccnz Llj_84
Lljd_85:
    s_mov_b64 exec, -1
    ds_read_b128 v[72:75], v150 offset:0
    ds_read_b128 v[84:87], v150 offset:3072
    ds_read_b128 v[76:79], v150 offset:1024
    ds_read_b128 v[88:91], v150 offset:4096
    ds_read_b128 v[80:83], v150 offset:2048
    ds_read_b128 v[92:95], v150 offset:5120
    s_waitcnt lgkmcnt(5)
    v_mfma_f32_16x16x32_bf16 v[96:99], v[72:75], v[216:219], 0
    s_waitcnt lgkmcnt(4)
    v_mfma_f32_16x16x32_bf16 v[100:103], v[84:87], v[216:219], 0
    s_waitcnt lgkmcnt(3)
    v_mfma_f32_16x16x32_bf16 v[96:99], v[76:79], v[220:223], v[96:99]
    s_waitcnt lgkmcnt(2)
    v_mfma_f32_16x16x32_bf16 v[100:103], v[88:91], v[220:223], v[100:103]
    s_waitcnt lgkmcnt(1)
    v_mfma_f32_16x16x32_bf16 v[96:99], v[80:83], v[224:227], v[96:99]
    s_waitcnt lgkmcnt(0)
    v_mfma_f32_16x16x32_bf16 v[100:103], v[92:95], v[224:227], v[100:103]
    v_mfma_f32_16x16x32_bf16 v[104:107], v[72:75], v[228:231], 0
    v_mfma_f32_16x16x32_bf16 v[108:111], v[84:87], v[228:231], 0
    v_mfma_f32_16x16x32_bf16 v[104:107], v[76:79], v[232:235], v[104:107]
    v_mfma_f32_16x16x32_bf16 v[108:111], v[88:91], v[232:235], v[108:111]
    v_mfma_f32_16x16x32_bf16 v[104:107], v[80:83], v[236:239], v[104:107]
    v_mfma_f32_16x16x32_bf16 v[108:111], v[92:95], v[236:239], v[108:111]
    v_mfma_f32_16x16x32_bf16 v[112:115], v[72:75], v[240:243], 0
    v_cvt_pk_bf16_f32 v120, v96, v97
    v_mfma_f32_16x16x32_bf16 v[116:119], v[84:87], v[240:243], 0
    v_cvt_pk_bf16_f32 v121, v98, v99
    v_mfma_f32_16x16x32_bf16 v[112:115], v[76:79], v[244:247], v[112:115]
    v_cvt_pk_bf16_f32 v122, v100, v101
    v_mfma_f32_16x16x32_bf16 v[116:119], v[88:91], v[244:247], v[116:119]
    v_cvt_pk_bf16_f32 v123, v102, v103
    v_mfma_f32_16x16x32_bf16 v[112:115], v[80:83], v[248:251], v[112:115]
    buffer_store_dwordx4 v[120:123], v143, s[36:39], s54 offen nt
    v_mfma_f32_16x16x32_bf16 v[116:119], v[92:95], v[248:251], v[116:119]
    v_cvt_pk_bf16_f32 v124, v104, v105
    v_cvt_pk_bf16_f32 v125, v106, v107
    v_cvt_pk_bf16_f32 v126, v108, v109
    v_cvt_pk_bf16_f32 v127, v110, v111
    buffer_store_dwordx4 v[124:127], v144, s[36:39], s54 offen nt
    s_nop 0
    v_cvt_pk_bf16_f32 v128, v112, v113
    v_cvt_pk_bf16_f32 v129, v114, v115
    v_cvt_pk_bf16_f32 v130, v116, v117
    v_cvt_pk_bf16_f32 v131, v118, v119
    buffer_store_dwordx4 v[128:131], v145, s[36:39], s54 offen nt
    s_endpgm
L_exit:
    s_endpgm
.section .rodata,"a"
.p2align 6
.amdhsa_kernel concat_heads__spectral_gfnet__ssm_conv_h3__prompt_kernel
  .amdhsa_next_free_vgpr 256
  .amdhsa_next_free_sgpr 100
  .amdhsa_accum_offset 256
  .amdhsa_group_segment_fixed_size 0
  .amdhsa_kernarg_size 96
  .amdhsa_user_sgpr_count 2
  .amdhsa_user_sgpr_kernarg_segment_ptr 1
  .amdhsa_system_sgpr_workgroup_id_x 1
  .amdhsa_float_denorm_mode_32 3
.end_amdhsa_kernel
```
